```python
import torch

def _softmax(x, axis=-1):
    return torch.softmax(x, dim=axis)
def _gelu(x):
    return torch.nn.functional.gelu(x, approximate="tanh")
def _silu(x):
    return torch.nn.functional.silu(x)
def _sigmoid(x):
    return torch.sigmoid(x)
def _layernorm(x, axis=-1, eps=1e-5):
    m = x.mean(dim=axis, keepdim=True)
    v = x.var(dim=axis, keepdim=True, unbiased=False)
    return (x - m) / torch.sqrt(v + eps)
def _scatter_add(tgt, idx, src, axis=0):
    return tgt.clone().index_add_(axis, idx, src)
def _segment_sum(src, seg, n):
    out = torch.zeros((n,) + src.shape[1:], dtype=src.dtype)
    return out.index_add_(0, seg, src)
def _pad(x, pw):
    flat = tuple(v for pair in reversed(pw) for v in pair)
    return torch.nn.functional.pad(x, flat)

kernel_name = 'concat_heads__gqa_block_cached__gqa_block_cached__decode'

def setup_inputs():

    _w = (lambda a: (lambda t: t.to(torch.bfloat16) if t.is_floating_point() else t)(torch.as_tensor(a)))
    def _A_setup():
        B, Sq, D = 4, 1, 512
        Hq, Hkv, Sk, Dh = 32, 8, 4096, 128
        assert Hq % Hkv == 0, (Hq, Hkv)
        return {
            "x": _w((lambda *s: torch.randn(*s, dtype=torch.bfloat16) * 0.8)(B, Sq, D)),
            "k_cache": _w((lambda *s: torch.randn(*s, dtype=torch.bfloat16) * 0.8)(B, Hkv, Sk, Dh)),
            "v_cache": _w((lambda *s: torch.randn(*s, dtype=torch.bfloat16) * 0.05)(B, Hkv, Sk, Dh)),
            "wq": _w((lambda *s: torch.randn(*s, dtype=torch.bfloat16) * 0.8)(D, Hq * Dh) * (D ** -0.5)),
            "wo": _w((lambda *s: torch.randn(*s, dtype=torch.bfloat16) * 0.05)(Hq * Dh, D) * ((Hq * Dh) ** -0.5)),
        }
    _A_in = _A_setup()

    def _B_setup():
        B, Sq, D = 4, 1, 512
        Hq, Hkv, Sk, Dh = 32, 8, 4096, 128
        assert Hq % Hkv == 0, (Hq, Hkv)
        return {
            "x": _w((lambda *s: torch.randn(*s, dtype=torch.bfloat16) * 0.8)(B, Sq, D)),
            "k_cache": _w((lambda *s: torch.randn(*s, dtype=torch.bfloat16) * 0.8)(B, Hkv, Sk, Dh)),
            "v_cache": _w((lambda *s: torch.randn(*s, dtype=torch.bfloat16) * 0.05)(B, Hkv, Sk, Dh)),
            "wq": _w((lambda *s: torch.randn(*s, dtype=torch.bfloat16) * 0.8)(D, Hq * Dh) * (D ** -0.5)),
            "wo": _w((lambda *s: torch.randn(*s, dtype=torch.bfloat16) * 0.05)(Hq * Dh, D) * ((Hq * Dh) ** -0.5)),
        }
    _B_in = _B_setup()

    return {
        "A_x": _A_in["x"],
        "A_k_cache": _A_in["k_cache"],
        "A_v_cache": _A_in["v_cache"],
        "A_wq": _A_in["wq"],
        "A_wo": _A_in["wo"],
        "B_x": _B_in["x"],
        "B_k_cache": _B_in["k_cache"],
        "B_v_cache": _B_in["v_cache"],
        "B_wq": _B_in["wq"],
        "B_wo": _B_in["wo"],
    }

def reference(A_x, A_k_cache, A_v_cache, A_wq, A_wo, B_x, B_k_cache, B_v_cache, B_wq, B_wo):
    def _A_ref(x, k_cache, v_cache, wq, wo):
        B, Sq, D = x.shape
        Hq, Dh = 32, 128
        Hkv = k_cache.shape[1]
        rep = Hq // Hkv
        q = (lambda x, *d: x.permute(*d))((x @ wq).reshape(B, Sq, Hq, Dh), 0, 2, 1, 3)
        k = (lambda x, n, axis: torch.repeat_interleave(x, n, dim=axis))(k_cache, rep, axis=1)
        v = (lambda x, n, axis: torch.repeat_interleave(x, n, dim=axis))(v_cache, rep, axis=1)
        scores = torch.einsum("bhqd,bhkd->bhqk", q, k) * (Dh ** -0.5)
        p = _softmax(scores, axis=-1)
        o = torch.einsum("bhqk,bhkd->bhqd", p, v)
        return (lambda x, *d: x.permute(*d))(o, 0, 2, 1, 3).reshape(B, Sq, Hq * Dh) @ wo

    def _B_ref(x, k_cache, v_cache, wq, wo):
        B, Sq, D = x.shape
        Hq, Dh = 32, 128
        Hkv = k_cache.shape[1]
        rep = Hq // Hkv
        q = (lambda x, *d: x.permute(*d))((x @ wq).reshape(B, Sq, Hq, Dh), 0, 2, 1, 3)
        k = (lambda x, n, axis: torch.repeat_interleave(x, n, dim=axis))(k_cache, rep, axis=1)
        v = (lambda x, n, axis: torch.repeat_interleave(x, n, dim=axis))(v_cache, rep, axis=1)
        scores = torch.einsum("bhqd,bhkd->bhqk", q, k) * (Dh ** -0.5)
        p = _softmax(scores, axis=-1)
        o = torch.einsum("bhqk,bhkd->bhqd", p, v)
        return (lambda x, *d: x.permute(*d))(o, 0, 2, 1, 3).reshape(B, Sq, Hq * Dh) @ wo

    a = _A_ref(A_x, A_k_cache, A_v_cache, A_wq, A_wo)
    b = _B_ref(B_x, B_k_cache, B_v_cache, B_wq, B_wo)
    return torch.concatenate([a, b], axis=-1)
```

```asm
; @launch grid=(256,1,1) block=(512,1,1) lds=65536
.amdgcn_target "amdgcn-amd-amdhsa--gfx950"
.text
.globl concat_heads__gqa_block_cached__gqa_block_cached__decode_kernel
.p2align 8
.type concat_heads__gqa_block_cached__gqa_block_cached__decode_kernel,@function
concat_heads__gqa_block_cached__gqa_block_cached__decode_kernel:
    s_cmp_ge_u32 s2, 256
    s_cbranch_scc1 L_end
    s_bfe_u32 s28, s2, 0x10001
    s_mul_i32 s3, s28, 40
    s_add_u32 s4, s0, s3
    s_addc_u32 s5, s1, 0
    s_load_dwordx8 s[8:15], s[4:5], 0
    s_load_dwordx2 s[20:21], s[0:1], 96
    s_load_dwordx2 s[16:17], s[4:5], 32
    s_load_dwordx2 s[18:19], s[0:1], 80
    v_lshrrev_b32 v9, 6, v0
    v_and_b32 v0, 63, v0
    v_lshrrev_b32 v1, 4, v0
    v_readfirstlane_b32 s23, v9
    v_and_b32 v2, 15, v0
    s_bfe_u32 s24, s2, 0x20003
    s_bfe_u32 s25, s2, 0x10002
    s_lshl_b32 s25, s25, 1
    s_and_b32 s3, s2, 1
    s_or_b32 s25, s25, s3
    s_lshr_b32 s26, s2, 5
    s_lshr_b32 s54, s2, 3
    v_lshrrev_b32 v9, 2, v2
    v_lshlrev_b32 v4, 4, v2
    s_cmp_lg_u32 s23, 0
    s_cbranch_scc1 L_common
    v_and_b32 v11, 3, v2
    v_lshlrev_b32 v5, 18, v9
    v_lshl_add_u32 v5, v1, 16, v5
    v_lshl_add_u32 v5, v11, 4, v5
    v_lshlrev_b32 v10, 10, v11
    v_lshl_add_u32 v10, v9, 6, v10
    v_lshl_add_u32 v10, v1, 4, v10
    s_lshl_b32 s62, s25, 2
    s_add_u32 s62, s62, s24
    s_lshl_b32 s6, s26, 10
    s_lshl_b32 s29, s62, 6
    s_add_u32 s6, s6, s29
    s_sub_u32 s42, 0x400000, s6
    s_mov_b32 s43, 0x20000
    v_mov_b32 v12, 0
    v_mov_b32 v13, 0
    v_mov_b32 v14, 0
    v_mov_b32 v15, 0
    ds_write_b128 v13, v[12:15] offset:17792
    s_waitcnt lgkmcnt(0)
    s_add_u32 s40, s14, s6
    s_addc_u32 s41, s15, 0
    buffer_load_dwordx4 v[112:115], v5, s[40:43], 0 offen
    s_mov_b32 s3, 8192
    buffer_load_dwordx4 v[116:119], v5, s[40:43], s3 offen
    s_mov_b32 s3, 16384
    buffer_load_dwordx4 v[120:123], v5, s[40:43], s3 offen
    s_mov_b32 s3, 24576
    buffer_load_dwordx4 v[124:127], v5, s[40:43], s3 offen
    s_mov_b32 s3, 32768
    buffer_load_dwordx4 v[128:131], v5, s[40:43], s3 offen
    s_mov_b32 s3, 40960
    buffer_load_dwordx4 v[132:135], v5, s[40:43], s3 offen
    s_mov_b32 s3, 49152
    buffer_load_dwordx4 v[136:139], v5, s[40:43], s3 offen
    s_mov_b32 s3, 57344
    buffer_load_dwordx4 v[140:143], v5, s[40:43], s3 offen
    global_load_dwordx4 v[16:19], v10, s[8:9] offset:0
    s_mov_b32 s3, 1048576
    buffer_load_dwordx4 v[144:147], v5, s[40:43], s3 offen
    s_mov_b32 s3, 1056768
    buffer_load_dwordx4 v[148:151], v5, s[40:43], s3 offen
    s_mov_b32 s3, 1064960
    buffer_load_dwordx4 v[152:155], v5, s[40:43], s3 offen
    s_mov_b32 s3, 1073152
    buffer_load_dwordx4 v[156:159], v5, s[40:43], s3 offen
    s_mov_b32 s3, 1081344
    buffer_load_dwordx4 v[160:163], v5, s[40:43], s3 offen
    s_mov_b32 s3, 1089536
    buffer_load_dwordx4 v[164:167], v5, s[40:43], s3 offen
    s_mov_b32 s3, 1097728
    buffer_load_dwordx4 v[168:171], v5, s[40:43], s3 offen
    s_mov_b32 s3, 1105920
    buffer_load_dwordx4 v[172:175], v5, s[40:43], s3 offen
    global_load_dwordx4 v[20:23], v10, s[8:9] offset:256
    s_mov_b32 s3, 2097152
    buffer_load_dwordx4 v[176:179], v5, s[40:43], s3 offen
    s_mov_b32 s3, 2105344
    buffer_load_dwordx4 v[180:183], v5, s[40:43], s3 offen
    s_mov_b32 s3, 2113536
    buffer_load_dwordx4 v[184:187], v5, s[40:43], s3 offen
    s_mov_b32 s3, 2121728
    buffer_load_dwordx4 v[188:191], v5, s[40:43], s3 offen
    s_mov_b32 s3, 2129920
    buffer_load_dwordx4 v[192:195], v5, s[40:43], s3 offen
    s_mov_b32 s3, 2138112
    buffer_load_dwordx4 v[196:199], v5, s[40:43], s3 offen
    s_mov_b32 s3, 2146304
    buffer_load_dwordx4 v[200:203], v5, s[40:43], s3 offen
    s_mov_b32 s3, 2154496
    buffer_load_dwordx4 v[204:207], v5, s[40:43], s3 offen
    global_load_dwordx4 v[24:27], v10, s[8:9] offset:512
    s_mov_b32 s3, 3145728
    buffer_load_dwordx4 v[208:211], v5, s[40:43], s3 offen
    s_mov_b32 s3, 3153920
    buffer_load_dwordx4 v[212:215], v5, s[40:43], s3 offen
    s_mov_b32 s3, 3162112
    buffer_load_dwordx4 v[216:219], v5, s[40:43], s3 offen
    s_mov_b32 s3, 3170304
    buffer_load_dwordx4 v[220:223], v5, s[40:43], s3 offen
    s_mov_b32 s3, 3178496
    buffer_load_dwordx4 v[224:227], v5, s[40:43], s3 offen
    s_mov_b32 s3, 3186688
    buffer_load_dwordx4 v[228:231], v5, s[40:43], s3 offen
    s_mov_b32 s3, 3194880
    buffer_load_dwordx4 v[232:235], v5, s[40:43], s3 offen
    s_mov_b32 s3, 3203072
    buffer_load_dwordx4 v[236:239], v5, s[40:43], s3 offen
    global_load_dwordx4 v[28:31], v10, s[8:9] offset:768
L_common:
    v_and_b32 v3, 7, v2
    v_lshlrev_b32 v3, 8, v3
    v_lshl_add_u32 v3, v1, 4, v3
    v_lshrrev_b32 v8, 3, v2
    v_lshl_add_u32 v3, v8, 6, v3
    v_lshl_add_u32 v4, v1, 10, v4
    s_lshl_b32 s7, s24, 3
    s_add_u32 s7, s7, s26
    s_lshl_b32 s7, s7, 20
    s_add_u32 s44, s25, s24
    s_and_b32 s44, s44, 3
    s_lshl_b32 s44, s44, 3
    s_add_u32 s29, s54, s23
    s_and_b32 s29, s29, 7
    s_add_u32 s44, s44, s29
    s_lshl_b32 s44, s44, 15
    s_add_u32 s45, s44, 4096
    s_add_u32 s46, s44, 8192
    s_add_u32 s47, s44, 12288
    s_add_u32 s48, s44, 16384
    s_add_u32 s49, s44, 20480
    s_add_u32 s50, s44, 24576
    s_mov_b32 s34, 0x100000
    s_mov_b32 s35, 0x20000
    s_waitcnt lgkmcnt(0)
    s_add_u32 s32, s10, s7
    s_addc_u32 s33, s11, 0
    s_lshl_b32 s3, s28, 7
    s_add_u32 s3, s3, 3145728
    s_add_u32 s74, s20, s3
    s_addc_u32 s75, s21, 0
    s_load_dword s22, s[74:75], 0
    s_barrier
    s_cmp_eq_u32 s23, 0
    s_cbranch_scc1 L_setup
    buffer_load_dwordx4 v[112:115], v3, s[32:35], s44 offen offset:0 nt
    buffer_load_dwordx4 v[116:119], v3, s[32:35], s44 offen offset:128 nt
    buffer_load_dwordx4 v[120:123], v3, s[32:35], s44 offen offset:2048 nt
    buffer_load_dwordx4 v[124:127], v3, s[32:35], s44 offen offset:2176 nt
    buffer_load_dwordx4 v[128:131], v3, s[32:35], s45 offen offset:0 nt
    buffer_load_dwordx4 v[132:135], v3, s[32:35], s45 offen offset:128 nt
    buffer_load_dwordx4 v[136:139], v3, s[32:35], s45 offen offset:2048 nt
    buffer_load_dwordx4 v[140:143], v3, s[32:35], s45 offen offset:2176 nt
L_setup:
    s_add_u32 s36, s12, s7
    s_addc_u32 s37, s13, 0
    s_mov_b32 s38, 0x100000
    s_mov_b32 s39, 0x20000
    s_mov_b32 s30, 0x05040100
    s_mov_b32 s31, 0x07060302
    s_lshl_b32 s27, s28, 3
    s_add_u32 s27, s27, s26
    s_lshl_b32 s3, s27, 15
    s_add_u32 s29, s3, 1048576
    s_add_u32 s60, s20, s29
    s_addc_u32 s61, s21, 0
    s_lshl_b32 s3, s28, 19
    s_add_u32 s29, s3, 2097152
    s_add_u32 s64, s20, s29
    s_addc_u32 s65, s21, 0
    s_mov_b32 s66, 0x80000
    s_mov_b32 s67, 0x20000
    s_mov_b32 s68, 0x20000
    s_mov_b32 s69, 0x40000
    s_mov_b32 s70, 0x60000
    s_mov_b32 s71, 0x3e0293ee
    s_and_b32 s63, s23, 3
    s_lshl_b32 s3, s27, 4
    s_lshl_b32 s4, s24, 2
    s_add_u32 s4, s4, s3
    s_add_u32 s4, s4, s63
    s_lshl_b32 s4, s4, 7
    s_add_u32 s55, s4, 262144
    s_add_u32 s58, s20, s55
    s_addc_u32 s59, s21, 0
    s_lshl_b32 s4, s63, 2
    s_add_u32 s4, s4, s3
    s_add_u32 s4, s4, s25
    s_lshl_b32 s4, s4, 7
    s_add_u32 s4, s4, 262144
    s_add_u32 s10, s20, s4
    s_addc_u32 s11, s21, 0
    s_lshl_b32 s3, s24, 11
    s_lshl_b32 s29, s25, 9
    s_add_u32 s3, s3, s29
    s_lshl_b32 s29, s63, 7
    s_add_u32 s3, s3, s29
    v_lshrrev_b32 v6, 1, v2
    v_lshlrev_b32 v6, 4, v6
    v_lshl_add_u32 v6, v1, 13, v6
    v_add_u32 v6, s3, v6
    s_lshl_b32 s3, s24, 13
    s_lshl_b32 s29, s63, 11
    s_add_u32 s3, s3, s29
    v_lshlrev_b32 v7, 4, v0
    v_add_u32 v7, s3, v7
    v_lshlrev_b32 v8, 2, v0
    s_lshl_b32 s3, s54, 17
    s_lshl_b32 s29, s63, 15
    s_add_u32 s3, s3, s29
    s_lshl_b32 s29, s25, 8
    s_add_u32 s3, s3, s29
    s_add_u32 s12, s16, s3
    s_addc_u32 s13, s17, 0
    s_mov_b32 s14, 0x8000
    s_mov_b32 s15, 0x20000
    s_lshl_b32 s16, s63, 13
    s_add_u32 s16, s16, 32768
    s_mov_b32 s17, 1
    v_mov_b32 v108, 0x3f803f80
    v_mov_b32 v109, 0x3f803f80
    v_mov_b32 v110, 0x3f803f80
    v_mov_b32 v111, 0x3f803f80
    v_mov_b32 v13, 0
    s_waitcnt lgkmcnt(0)
    s_add_u32 s22, s22, 1
    s_cmp_eq_u32 s23, 0
    s_cbranch_scc1 L_service
    s_barrier
    buffer_load_dwordx4 v[144:147], v3, s[32:35], s46 offen offset:0 nt
    buffer_load_dwordx4 v[148:151], v3, s[32:35], s46 offen offset:128 nt
    buffer_load_dwordx4 v[152:155], v3, s[32:35], s46 offen offset:2048 nt
    buffer_load_dwordx4 v[156:159], v3, s[32:35], s46 offen offset:2176 nt
    buffer_load_dwordx4 v[160:163], v3, s[32:35], s47 offen offset:0 nt
    buffer_load_dwordx4 v[164:167], v3, s[32:35], s47 offen offset:128 nt
    buffer_load_dwordx4 v[168:171], v3, s[32:35], s47 offen offset:2048 nt
    buffer_load_dwordx4 v[172:175], v3, s[32:35], s47 offen offset:2176 nt
    buffer_load_dwordx4 v[176:179], v3, s[32:35], s48 offen offset:0 nt
    buffer_load_dwordx4 v[180:183], v3, s[32:35], s48 offen offset:128 nt
    buffer_load_dwordx4 v[184:187], v3, s[32:35], s48 offen offset:2048 nt
    buffer_load_dwordx4 v[188:191], v3, s[32:35], s48 offen offset:2176 nt
    buffer_load_dwordx4 v[192:195], v3, s[32:35], s49 offen offset:0 nt
    buffer_load_dwordx4 v[196:199], v3, s[32:35], s49 offen offset:128 nt
    buffer_load_dwordx4 v[200:203], v3, s[32:35], s49 offen offset:2048 nt
    buffer_load_dwordx4 v[204:207], v3, s[32:35], s49 offen offset:2176 nt
    buffer_load_dwordx4 v[208:211], v3, s[32:35], s50 offen offset:0 nt
    buffer_load_dwordx4 v[212:215], v3, s[32:35], s50 offen offset:128 nt
    buffer_load_dwordx4 v[216:219], v3, s[32:35], s50 offen offset:2048 nt
    buffer_load_dwordx4 v[220:223], v3, s[32:35], s50 offen offset:2176 nt
    s_branch L_qwait
L_service:
    s_getreg_b32 s7, hwreg(HW_REG_XCC_ID, 0, 4)
    v_cmp_eq_u32 s[4:5], v1, v9
    v_lshlrev_b32 v11, 4, v2
    v_and_b32 v12, 1, v0
    v_lshlrev_b32 v12, 10, v12
    v_bfe_u32 v14, v0, 1, 2
    v_lshl_add_u32 v12, v14, 4, v12
    v_bfe_u32 v14, v0, 3, 2
    v_lshl_add_u32 v12, v14, 2, v12
    v_and_b32 v15, 7, v0
    v_lshlrev_b32 v15, 4, v15
    v_lshl_add_u32 v15, v14, 11, v15
    s_lshl_b32 s6, s27, 13
    s_add_u32 s6, s6, 65536
    s_lshl_b32 s3, s62, 7
    s_add_u32 s3, s3, s6
    v_add_u32 v15, s3, v15
    s_lshl_b32 s3, s24, 11
    s_add_u32 s3, s3, s6
    v_lshlrev_b32 v104, 4, v0
    v_add_u32 v14, s3, v104
    s_lshl_b32 s3, s28, 11
    s_add_u32 s3, s3, 32768
    s_lshl_b32 s6, s25, 9
    s_add_u32 s6, s6, s3
    s_lshl_b32 s8, s54, 4
    v_add_u32 v104, s6, v104
    s_add_u32 s3, s3, s8
    v_and_b32 v106, 3, v0
    v_lshlrev_b32 v105, 9, v106
    v_add_u32 v105, s3, v105
    v_cmp_gt_u32 vcc, 32, v0
    s_add_u32 s6, s6, s8
    v_lshlrev_b32 v106, 7, v106
    v_add_u32 v106, s55, v106
    v_cndmask_b32 v104, v105, v104, vcc
    v_cmp_gt_u32 vcc, 36, v0
    s_lshl_b32 s3, s25, 7
    s_add_u32 s3, s3, s55
    v_cndmask_b32 v104, v106, v104, vcc
    v_writelane_b32 v15, s6, 32
    v_writelane_b32 v15, s3, 33
    s_waitcnt vmcnt(34)
    v_perm_b32 v36, v116, v112, s30
    v_perm_b32 v40, v116, v112, s31
    v_perm_b32 v44, v117, v113, s30
    v_perm_b32 v48, v117, v113, s31
    v_perm_b32 v52, v118, v114, s30
    v_perm_b32 v56, v118, v114, s31
    v_perm_b32 v60, v119, v115, s30
    v_perm_b32 v64, v119, v115, s31
    s_waitcnt vmcnt(32)
    v_perm_b32 v37, v124, v120, s30
    v_perm_b32 v41, v124, v120, s31
    v_perm_b32 v45, v125, v121, s30
    v_perm_b32 v49, v125, v121, s31
    v_perm_b32 v53, v126, v122, s30
    v_perm_b32 v57, v126, v122, s31
    v_perm_b32 v61, v127, v123, s30
    v_perm_b32 v65, v127, v123, s31
    s_waitcnt vmcnt(30)
    v_perm_b32 v38, v132, v128, s30
    v_perm_b32 v42, v132, v128, s31
    v_perm_b32 v46, v133, v129, s30
    v_perm_b32 v50, v133, v129, s31
    v_perm_b32 v54, v134, v130, s30
    v_perm_b32 v58, v134, v130, s31
    v_perm_b32 v62, v135, v131, s30
    v_perm_b32 v66, v135, v131, s31
    s_waitcnt vmcnt(27)
    v_perm_b32 v39, v140, v136, s30
    v_perm_b32 v43, v140, v136, s31
    v_perm_b32 v47, v141, v137, s30
    v_perm_b32 v51, v141, v137, s31
    v_perm_b32 v55, v142, v138, s30
    v_perm_b32 v59, v142, v138, s31
    v_perm_b32 v63, v143, v139, s30
    v_perm_b32 v67, v143, v139, s31
    v_mfma_f32_16x16x32_bf16 v[72:75], v[16:19], v[36:39], 0
    v_mfma_f32_16x16x32_bf16 v[76:79], v[16:19], v[40:43], 0
    v_mfma_f32_16x16x32_bf16 v[80:83], v[16:19], v[44:47], 0
    v_mfma_f32_16x16x32_bf16 v[84:87], v[16:19], v[48:51], 0
    v_mfma_f32_16x16x32_bf16 v[88:91], v[16:19], v[52:55], 0
    v_mfma_f32_16x16x32_bf16 v[92:95], v[16:19], v[56:59], 0
    v_mfma_f32_16x16x32_bf16 v[96:99], v[16:19], v[60:63], 0
    v_mfma_f32_16x16x32_bf16 v[100:103], v[16:19], v[64:67], 0
    s_waitcnt vmcnt(25)
    v_perm_b32 v36, v148, v144, s30
    v_perm_b32 v40, v148, v144, s31
    v_perm_b32 v44, v149, v145, s30
    v_perm_b32 v48, v149, v145, s31
    v_perm_b32 v52, v150, v146, s30
    v_perm_b32 v56, v150, v146, s31
    v_perm_b32 v60, v151, v147, s30
    v_perm_b32 v64, v151, v147, s31
    s_waitcnt vmcnt(23)
    v_perm_b32 v37, v156, v152, s30
    v_perm_b32 v41, v156, v152, s31
    v_perm_b32 v45, v157, v153, s30
    v_perm_b32 v49, v157, v153, s31
    v_perm_b32 v53, v158, v154, s30
    v_perm_b32 v57, v158, v154, s31
    v_perm_b32 v61, v159, v155, s30
    v_perm_b32 v65, v159, v155, s31
    s_waitcnt vmcnt(21)
    v_perm_b32 v38, v164, v160, s30
    v_perm_b32 v42, v164, v160, s31
    v_perm_b32 v46, v165, v161, s30
    v_perm_b32 v50, v165, v161, s31
    v_perm_b32 v54, v166, v162, s30
    v_perm_b32 v58, v166, v162, s31
    v_perm_b32 v62, v167, v163, s30
    v_perm_b32 v66, v167, v163, s31
    s_waitcnt vmcnt(18)
    v_perm_b32 v39, v172, v168, s30
    v_perm_b32 v43, v172, v168, s31
    v_perm_b32 v47, v173, v169, s30
    v_perm_b32 v51, v173, v169, s31
    v_perm_b32 v55, v174, v170, s30
    v_perm_b32 v59, v174, v170, s31
    v_perm_b32 v63, v175, v171, s30
    v_perm_b32 v67, v175, v171, s31
    v_mfma_f32_16x16x32_bf16 v[72:75], v[20:23], v[36:39], v[72:75]
    v_mfma_f32_16x16x32_bf16 v[76:79], v[20:23], v[40:43], v[76:79]
    v_mfma_f32_16x16x32_bf16 v[80:83], v[20:23], v[44:47], v[80:83]
    v_mfma_f32_16x16x32_bf16 v[84:87], v[20:23], v[48:51], v[84:87]
    v_mfma_f32_16x16x32_bf16 v[88:91], v[20:23], v[52:55], v[88:91]
    v_mfma_f32_16x16x32_bf16 v[92:95], v[20:23], v[56:59], v[92:95]
    v_mfma_f32_16x16x32_bf16 v[96:99], v[20:23], v[60:63], v[96:99]
    v_mfma_f32_16x16x32_bf16 v[100:103], v[20:23], v[64:67], v[100:103]
    s_waitcnt vmcnt(16)
    v_perm_b32 v36, v180, v176, s30
    v_perm_b32 v40, v180, v176, s31
    v_perm_b32 v44, v181, v177, s30
    v_perm_b32 v48, v181, v177, s31
    v_perm_b32 v52, v182, v178, s30
    v_perm_b32 v56, v182, v178, s31
    v_perm_b32 v60, v183, v179, s30
    v_perm_b32 v64, v183, v179, s31
    s_waitcnt vmcnt(14)
    v_perm_b32 v37, v188, v184, s30
    v_perm_b32 v41, v188, v184, s31
    v_perm_b32 v45, v189, v185, s30
    v_perm_b32 v49, v189, v185, s31
    v_perm_b32 v53, v190, v186, s30
    v_perm_b32 v57, v190, v186, s31
    v_perm_b32 v61, v191, v187, s30
    v_perm_b32 v65, v191, v187, s31
    s_waitcnt vmcnt(12)
    v_perm_b32 v38, v196, v192, s30
    v_perm_b32 v42, v196, v192, s31
    v_perm_b32 v46, v197, v193, s30
    v_perm_b32 v50, v197, v193, s31
    v_perm_b32 v54, v198, v194, s30
    v_perm_b32 v58, v198, v194, s31
    v_perm_b32 v62, v199, v195, s30
    v_perm_b32 v66, v199, v195, s31
    s_waitcnt vmcnt(9)
    v_perm_b32 v39, v204, v200, s30
    v_perm_b32 v43, v204, v200, s31
    v_perm_b32 v47, v205, v201, s30
    v_perm_b32 v51, v205, v201, s31
    v_perm_b32 v55, v206, v202, s30
    v_perm_b32 v59, v206, v202, s31
    v_perm_b32 v63, v207, v203, s30
    v_perm_b32 v67, v207, v203, s31
    v_mfma_f32_16x16x32_bf16 v[72:75], v[24:27], v[36:39], v[72:75]
    v_mfma_f32_16x16x32_bf16 v[76:79], v[24:27], v[40:43], v[76:79]
    v_mfma_f32_16x16x32_bf16 v[80:83], v[24:27], v[44:47], v[80:83]
    v_mfma_f32_16x16x32_bf16 v[84:87], v[24:27], v[48:51], v[84:87]
    v_mfma_f32_16x16x32_bf16 v[88:91], v[24:27], v[52:55], v[88:91]
    v_mfma_f32_16x16x32_bf16 v[92:95], v[24:27], v[56:59], v[92:95]
    v_mfma_f32_16x16x32_bf16 v[96:99], v[24:27], v[60:63], v[96:99]
    v_mfma_f32_16x16x32_bf16 v[100:103], v[24:27], v[64:67], v[100:103]
    s_waitcnt vmcnt(7)
    v_perm_b32 v36, v212, v208, s30
    v_perm_b32 v40, v212, v208, s31
    v_perm_b32 v44, v213, v209, s30
    v_perm_b32 v48, v213, v209, s31
    v_perm_b32 v52, v214, v210, s30
    v_perm_b32 v56, v214, v210, s31
    v_perm_b32 v60, v215, v211, s30
    v_perm_b32 v64, v215, v211, s31
    s_waitcnt vmcnt(5)
    v_perm_b32 v37, v220, v216, s30
    v_perm_b32 v41, v220, v216, s31
    v_perm_b32 v45, v221, v217, s30
    v_perm_b32 v49, v221, v217, s31
    v_perm_b32 v53, v222, v218, s30
    v_perm_b32 v57, v222, v218, s31
    v_perm_b32 v61, v223, v219, s30
    v_perm_b32 v65, v223, v219, s31
    s_waitcnt vmcnt(3)
    v_perm_b32 v38, v228, v224, s30
    v_perm_b32 v42, v228, v224, s31
    v_perm_b32 v46, v229, v225, s30
    v_perm_b32 v50, v229, v225, s31
    v_perm_b32 v54, v230, v226, s30
    v_perm_b32 v58, v230, v226, s31
    v_perm_b32 v62, v231, v227, s30
    v_perm_b32 v66, v231, v227, s31
    s_waitcnt vmcnt(0)
    v_perm_b32 v39, v236, v232, s30
    v_perm_b32 v43, v236, v232, s31
    v_perm_b32 v47, v237, v233, s30
    v_perm_b32 v51, v237, v233, s31
    v_perm_b32 v55, v238, v234, s30
    v_perm_b32 v59, v238, v234, s31
    v_perm_b32 v63, v239, v235, s30
    v_perm_b32 v67, v239, v235, s31
    v_mfma_f32_16x16x32_bf16 v[72:75], v[28:31], v[36:39], v[72:75]
    v_mfma_f32_16x16x32_bf16 v[76:79], v[28:31], v[40:43], v[76:79]
    v_mfma_f32_16x16x32_bf16 v[80:83], v[28:31], v[44:47], v[80:83]
    v_mfma_f32_16x16x32_bf16 v[84:87], v[28:31], v[48:51], v[84:87]
    v_mfma_f32_16x16x32_bf16 v[88:91], v[28:31], v[52:55], v[88:91]
    v_mfma_f32_16x16x32_bf16 v[92:95], v[28:31], v[56:59], v[92:95]
    v_mfma_f32_16x16x32_bf16 v[96:99], v[28:31], v[60:63], v[96:99]
    v_mfma_f32_16x16x32_bf16 v[100:103], v[28:31], v[64:67], v[100:103]
    v_mov_b32 v33, s22
    v_mov_b32 v35, s22
    s_mov_b64 exec, s[4:5]
    ds_write_b128 v11, v[72:75] offset:0
    ds_write_b128 v11, v[76:79] offset:256
    ds_write_b128 v11, v[80:83] offset:512
    ds_write_b128 v11, v[84:87] offset:768
    ds_write_b128 v11, v[88:91] offset:1024
    ds_write_b128 v11, v[92:95] offset:1280
    ds_write_b128 v11, v[96:99] offset:1536
    ds_write_b128 v11, v[100:103] offset:1792
    s_mov_b64 exec, -1
    ds_read2_b32 v[16:17], v12 offset0:0 offset1:16
    ds_read2_b32 v[18:19], v12 offset0:32 offset1:48
    ds_read2_b32 v[20:21], v12 offset0:64 offset1:80
    ds_read2_b32 v[22:23], v12 offset0:96 offset1:112
    ds_read2_b32 v[24:25], v12 offset0:128 offset1:144
    ds_read2_b32 v[26:27], v12 offset0:160 offset1:176
    ds_read2_b32 v[28:29], v12 offset0:192 offset1:208
    ds_read2_b32 v[30:31], v12 offset0:224 offset1:240
    s_waitcnt lgkmcnt(0)
    v_pk_add_f32 v[16:17], v[16:17], v[18:19]
    v_pk_add_f32 v[20:21], v[20:21], v[22:23]
    v_pk_add_f32 v[24:25], v[24:25], v[26:27]
    v_pk_add_f32 v[28:29], v[28:29], v[30:31]
    v_add_f32 v16, v16, v17
    v_add_f32 v20, v20, v21
    v_add_f32 v24, v24, v25
    v_add_f32 v28, v28, v29
    v_cvt_pk_bf16_f32 v32, v16, v20
    v_cvt_pk_bf16_f32 v34, v24, v28
    v_writelane_b32 v32, s7, 32
    v_writelane_b32 v34, s7, 32
    v_writelane_b32 v32, 0, 33
    v_writelane_b32 v34, 0, 33
    s_mov_b32 exec_hi, 3
    global_store_dwordx4 v15, v[32:35], s[20:21] sc1
    s_mov_b64 exec, -1
    s_barrier
    v_lshlrev_b32 v11, 3, v0
    v_add_u32 v11, 16384, v11
    s_mov_b32 s29, 2000000
    s_waitcnt vmcnt(0)
L_qpoll:
    global_load_dwordx4 v[16:19], v14, s[20:21] sc1
    global_load_dwordx4 v[20:23], v14, s[20:21] offset:1024 sc1
    global_load_dwordx4 v[24:27], v104, s[20:21] sc1
    s_waitcnt vmcnt(0)
    v_cmpx_eq_u32 vcc, s22, v17
    v_cmpx_eq_u32 vcc, s22, v19
    v_cmpx_eq_u32 vcc, s22, v21
    v_cmpx_eq_u32 vcc, s22, v23
    v_cmpx_eq_u32 vcc, s22, v25
    v_cmpx_eq_u32 vcc, s22, v27
    s_sub_u32 s29, s29, 1
    s_cselect_b64 s[72:73], -1, exec
    s_mov_b64 exec, -1
    s_cmp_eq_u64 s[72:73], -1
    s_cbranch_scc0 L_qpoll
    ds_write2_b32 v11, v16, v18 offset0:0 offset1:1
    ds_write2_b32 v11, v20, v22 offset0:128 offset1:129
    v_readlane_b32 s40, v24, 32
    v_readlane_b32 s41, v24, 33
    v_readlane_b32 s42, v24, 34
    v_readlane_b32 s43, v24, 35
    v_cmp_ne_u32 vcc, s7, v24
    s_and_b32 s40, s40, 1
    s_and_b32 s41, s41, 1
    s_and_b32 s42, s42, 1
    s_and_b32 s43, s43, 1
    s_add_u32 s41, s41, s40
    s_add_u32 s42, s42, s41
    s_add_u32 s43, s43, s42
    s_mul_i32 s3, s43, 9
    s_add_u32 s3, s3, 32
    s_mul_i32 s4, s3, 1
    s_mul_i32 s40, s40, 36
    s_sub_u32 s40, s4, s40
    s_add_u32 s40, s40, 2
    s_lshr_b32 s40, s40, 2
    s_mul_i32 s4, s3, 2
    s_mul_i32 s41, s41, 36
    s_sub_u32 s41, s4, s41
    s_add_u32 s41, s41, 2
    s_lshr_b32 s41, s41, 2
    s_mul_i32 s4, s3, 3
    s_mul_i32 s42, s42, 36
    s_sub_u32 s42, s4, s42
    s_add_u32 s42, s42, 2
    s_lshr_b32 s42, s42, 2
    s_lshl_b32 s41, s41, 8
    s_lshl_b32 s42, s42, 16
    s_or_b32 s40, s40, s41
    s_or_b32 s40, s40, s42
    s_or_b32 s41, s40, 0x20000000
    s_lshl_b32 s40, s40, 8
    s_lshl_b32 s3, s25, 3
    s_lshr_b32 s40, s40, s3
    s_lshr_b32 s41, s41, s3
    s_and_b32 s40, s40, 0xff
    s_and_b32 s41, s41, 0xff
    s_sub_u32 s41, s41, s40
    s_lshl_b32 s40, s40, 16
    s_lshl_b32 s41, s41, 8
    s_or_b32 s40, s40, s41
    s_cmp_eq_u32 vcc_lo, 0
    s_cselect_b32 s3, 3, 1
    s_or_b32 s40, s40, s3
    v_mov_b32 v10, s40
    ds_write_b32 v13, v10 offset:17792
    buffer_load_dwordx4 v[112:115], v3, s[32:35], s44 offen offset:0 nt
    buffer_load_dwordx4 v[116:119], v3, s[32:35], s44 offen offset:128 nt
    buffer_load_dwordx4 v[120:123], v3, s[32:35], s44 offen offset:2048 nt
    buffer_load_dwordx4 v[124:127], v3, s[32:35], s44 offen offset:2176 nt
    buffer_load_dwordx4 v[128:131], v3, s[32:35], s45 offen offset:0 nt
    buffer_load_dwordx4 v[132:135], v3, s[32:35], s45 offen offset:128 nt
    buffer_load_dwordx4 v[136:139], v3, s[32:35], s45 offen offset:2048 nt
    buffer_load_dwordx4 v[140:143], v3, s[32:35], s45 offen offset:2176 nt
    buffer_load_dwordx4 v[144:147], v3, s[32:35], s46 offen offset:0 nt
    buffer_load_dwordx4 v[148:151], v3, s[32:35], s46 offen offset:128 nt
    buffer_load_dwordx4 v[152:155], v3, s[32:35], s46 offen offset:2048 nt
    buffer_load_dwordx4 v[156:159], v3, s[32:35], s46 offen offset:2176 nt
    buffer_load_dwordx4 v[160:163], v3, s[32:35], s47 offen offset:0 nt
    buffer_load_dwordx4 v[164:167], v3, s[32:35], s47 offen offset:128 nt
    buffer_load_dwordx4 v[168:171], v3, s[32:35], s47 offen offset:2048 nt
    buffer_load_dwordx4 v[172:175], v3, s[32:35], s47 offen offset:2176 nt
    buffer_load_dwordx4 v[176:179], v3, s[32:35], s48 offen offset:0 nt
    buffer_load_dwordx4 v[180:183], v3, s[32:35], s48 offen offset:128 nt
    buffer_load_dwordx4 v[184:187], v3, s[32:35], s48 offen offset:2048 nt
    buffer_load_dwordx4 v[188:191], v3, s[32:35], s48 offen offset:2176 nt
    buffer_load_dwordx4 v[192:195], v3, s[32:35], s49 offen offset:0 nt
    buffer_load_dwordx4 v[196:199], v3, s[32:35], s49 offen offset:128 nt
    buffer_load_dwordx4 v[200:203], v3, s[32:35], s49 offen offset:2048 nt
    buffer_load_dwordx4 v[204:207], v3, s[32:35], s49 offen offset:2176 nt
    buffer_load_dwordx4 v[208:211], v3, s[32:35], s50 offen offset:0 nt
    buffer_load_dwordx4 v[212:215], v3, s[32:35], s50 offen offset:128 nt
    buffer_load_dwordx4 v[216:219], v3, s[32:35], s50 offen offset:2048 nt
    buffer_load_dwordx4 v[220:223], v3, s[32:35], s50 offen offset:2176 nt
L_qwait:
    ds_read_b32 v10, v13 offset:17792
    s_waitcnt lgkmcnt(0)
    v_readfirstlane_b32 s53, v10
    s_cmp_lg_u32 s53, 0
    s_cbranch_scc1 L_qready
    s_sleep 2
    s_branch L_qwait
L_qready:
    v_lshlrev_b32 v10, 8, v9
    v_lshl_add_u32 v10, v1, 4, v10
    v_and_b32 v11, 1, v2
    v_lshl_add_u32 v10, v11, 6, v10
    ds_read_b128 v[16:19], v10 offset:16384
    ds_read_b128 v[20:23], v10 offset:16512
    v_and_b32 v10, 3, v2
    v_cmp_eq_u32 s[56:57], 0, v10
    s_lshl_b32 s3, s23, 3
    v_lshlrev_b32 v11, 6, v9
    v_add_u32 v11, s3, v11
    v_lshlrev_b32 v12, 6, v1
    v_add_u32 v14, s3, v12
    s_lshl_b32 s3, s23, 11
    v_add_u32 v15, s3, v8
    s_bfe_u32 s3, s53, 0x80010
    s_add_u32 s3, s3, s23
    s_lshl_b32 s3, s3, 3
    s_add_u32 s3, s3, 7
    s_lshl_b32 s51, s3, 12
    s_add_u32 s52, s51, 0x40000
    s_bfe_u32 s3, s53, 0x80008
    s_cmp_le_u32 s3, s23
    s_cbranch_scc1 L_body7
    s_add_u32 s4, s23, 8
    s_cmp_gt_u32 s3, s4
    s_cbranch_scc1 L_body9
L_body8:
    buffer_load_dwordx4 v[224:227], v3, s[32:35], s51 offen offset:0 nt
    buffer_load_dwordx4 v[228:231], v3, s[32:35], s51 offen offset:128 nt
    buffer_load_dwordx4 v[232:235], v3, s[32:35], s51 offen offset:2048 nt
    buffer_load_dwordx4 v[236:239], v3, s[32:35], s51 offen offset:2176 nt
    s_waitcnt lgkmcnt(0)
    s_waitcnt vmcnt(28)
    v_mfma_f32_16x16x32_bf16 v[72:75], v[112:115], v[16:19], 0
    v_mfma_f32_16x16x32_bf16 v[72:75], v[116:119], v[20:23], v[72:75]
    v_mfma_f32_16x16x32_bf16 v[76:79], v[120:123], v[16:19], 0
    v_mfma_f32_16x16x32_bf16 v[76:79], v[124:127], v[20:23], v[76:79]
    buffer_load_dwordx4 v[112:115], v4, s[36:39], s44 offen offset:0 nt
    buffer_load_dwordx4 v[116:119], v4, s[36:39], s44 offen offset:256 nt
    buffer_load_dwordx4 v[120:123], v4, s[36:39], s44 offen offset:512 nt
    buffer_load_dwordx4 v[124:127], v4, s[36:39], s44 offen offset:768 nt
    s_waitcnt vmcnt(28)
    v_mfma_f32_16x16x32_bf16 v[80:83], v[128:131], v[16:19], 0
    v_mfma_f32_16x16x32_bf16 v[80:83], v[132:135], v[20:23], v[80:83]
    v_mfma_f32_16x16x32_bf16 v[84:87], v[136:139], v[16:19], 0
    v_mfma_f32_16x16x32_bf16 v[84:87], v[140:143], v[20:23], v[84:87]
    buffer_load_dwordx4 v[128:131], v4, s[36:39], s45 offen offset:0 nt
    buffer_load_dwordx4 v[132:135], v4, s[36:39], s45 offen offset:256 nt
    buffer_load_dwordx4 v[136:139], v4, s[36:39], s45 offen offset:512 nt
    buffer_load_dwordx4 v[140:143], v4, s[36:39], s45 offen offset:768 nt
    v_permlane32_swap_b32 v72, v76
    v_permlane32_swap_b32 v73, v77
    v_permlane32_swap_b32 v74, v78
    v_permlane32_swap_b32 v75, v79
    s_nop 0
    v_add_f32_dpp v36, v76, v72 quad_perm:[1,0,3,2] row_mask:0xf bank_mask:0xf
    v_add_f32_dpp v37, v77, v73 quad_perm:[1,0,3,2] row_mask:0xf bank_mask:0xf
    v_add_f32_dpp v38, v78, v74 quad_perm:[1,0,3,2] row_mask:0xf bank_mask:0xf
    v_add_f32_dpp v39, v79, v75 quad_perm:[1,0,3,2] row_mask:0xf bank_mask:0xf
    s_waitcnt vmcnt(28)
    v_mfma_f32_16x16x32_bf16 v[72:75], v[144:147], v[16:19], 0
    v_mfma_f32_16x16x32_bf16 v[72:75], v[148:151], v[20:23], v[72:75]
    v_mfma_f32_16x16x32_bf16 v[76:79], v[152:155], v[16:19], 0
    v_mfma_f32_16x16x32_bf16 v[76:79], v[156:159], v[20:23], v[76:79]
    buffer_load_dwordx4 v[144:147], v4, s[36:39], s46 offen offset:0 nt
    buffer_load_dwordx4 v[148:151], v4, s[36:39], s46 offen offset:256 nt
    buffer_load_dwordx4 v[152:155], v4, s[36:39], s46 offen offset:512 nt
    buffer_load_dwordx4 v[156:159], v4, s[36:39], s46 offen offset:768 nt
    v_permlane32_swap_b32 v80, v84
    v_permlane32_swap_b32 v81, v85
    v_permlane32_swap_b32 v82, v86
    v_permlane32_swap_b32 v83, v87
    s_nop 0
    v_add_f32_dpp v40, v84, v80 quad_perm:[1,0,3,2] row_mask:0xf bank_mask:0xf
    v_add_f32_dpp v41, v85, v81 quad_perm:[1,0,3,2] row_mask:0xf bank_mask:0xf
    v_add_f32_dpp v42, v86, v82 quad_perm:[1,0,3,2] row_mask:0xf bank_mask:0xf
    v_add_f32_dpp v43, v87, v83 quad_perm:[1,0,3,2] row_mask:0xf bank_mask:0xf
    s_waitcnt vmcnt(28)
    v_mfma_f32_16x16x32_bf16 v[80:83], v[160:163], v[16:19], 0
    v_mfma_f32_16x16x32_bf16 v[80:83], v[164:167], v[20:23], v[80:83]
    v_mfma_f32_16x16x32_bf16 v[84:87], v[168:171], v[16:19], 0
    v_mfma_f32_16x16x32_bf16 v[84:87], v[172:175], v[20:23], v[84:87]
    buffer_load_dwordx4 v[160:163], v4, s[36:39], s47 offen offset:0 nt
    buffer_load_dwordx4 v[164:167], v4, s[36:39], s47 offen offset:256 nt
    buffer_load_dwordx4 v[168:171], v4, s[36:39], s47 offen offset:512 nt
    buffer_load_dwordx4 v[172:175], v4, s[36:39], s47 offen offset:768 nt
    v_permlane32_swap_b32 v72, v76
    v_permlane32_swap_b32 v73, v77
    v_permlane32_swap_b32 v74, v78
    v_permlane32_swap_b32 v75, v79
    s_nop 0
    v_add_f32_dpp v44, v76, v72 quad_perm:[1,0,3,2] row_mask:0xf bank_mask:0xf
    v_add_f32_dpp v45, v77, v73 quad_perm:[1,0,3,2] row_mask:0xf bank_mask:0xf
    v_add_f32_dpp v46, v78, v74 quad_perm:[1,0,3,2] row_mask:0xf bank_mask:0xf
    v_add_f32_dpp v47, v79, v75 quad_perm:[1,0,3,2] row_mask:0xf bank_mask:0xf
    s_waitcnt vmcnt(28)
    v_mfma_f32_16x16x32_bf16 v[72:75], v[176:179], v[16:19], 0
    v_mfma_f32_16x16x32_bf16 v[72:75], v[180:183], v[20:23], v[72:75]
    v_mfma_f32_16x16x32_bf16 v[76:79], v[184:187], v[16:19], 0
    v_mfma_f32_16x16x32_bf16 v[76:79], v[188:191], v[20:23], v[76:79]
    buffer_load_dwordx4 v[176:179], v4, s[36:39], s48 offen offset:0 nt
    buffer_load_dwordx4 v[180:183], v4, s[36:39], s48 offen offset:256 nt
    buffer_load_dwordx4 v[184:187], v4, s[36:39], s48 offen offset:512 nt
    buffer_load_dwordx4 v[188:191], v4, s[36:39], s48 offen offset:768 nt
    v_permlane32_swap_b32 v80, v84
    v_permlane32_swap_b32 v81, v85
    v_permlane32_swap_b32 v82, v86
    v_permlane32_swap_b32 v83, v87
    s_nop 0
    v_add_f32_dpp v48, v84, v80 quad_perm:[1,0,3,2] row_mask:0xf bank_mask:0xf
    v_add_f32_dpp v49, v85, v81 quad_perm:[1,0,3,2] row_mask:0xf bank_mask:0xf
    v_add_f32_dpp v50, v86, v82 quad_perm:[1,0,3,2] row_mask:0xf bank_mask:0xf
    v_add_f32_dpp v51, v87, v83 quad_perm:[1,0,3,2] row_mask:0xf bank_mask:0xf
    s_waitcnt vmcnt(28)
    v_mfma_f32_16x16x32_bf16 v[80:83], v[192:195], v[16:19], 0
    v_mfma_f32_16x16x32_bf16 v[80:83], v[196:199], v[20:23], v[80:83]
    v_mfma_f32_16x16x32_bf16 v[84:87], v[200:203], v[16:19], 0
    v_mfma_f32_16x16x32_bf16 v[84:87], v[204:207], v[20:23], v[84:87]
    buffer_load_dwordx4 v[192:195], v4, s[36:39], s49 offen offset:0 nt
    buffer_load_dwordx4 v[196:199], v4, s[36:39], s49 offen offset:256 nt
    buffer_load_dwordx4 v[200:203], v4, s[36:39], s49 offen offset:512 nt
    buffer_load_dwordx4 v[204:207], v4, s[36:39], s49 offen offset:768 nt
    v_permlane32_swap_b32 v72, v76
    v_permlane32_swap_b32 v73, v77
    v_permlane32_swap_b32 v74, v78
    v_permlane32_swap_b32 v75, v79
    s_nop 0
    v_add_f32_dpp v52, v76, v72 quad_perm:[1,0,3,2] row_mask:0xf bank_mask:0xf
    v_add_f32_dpp v53, v77, v73 quad_perm:[1,0,3,2] row_mask:0xf bank_mask:0xf
    v_add_f32_dpp v54, v78, v74 quad_perm:[1,0,3,2] row_mask:0xf bank_mask:0xf
    v_add_f32_dpp v55, v79, v75 quad_perm:[1,0,3,2] row_mask:0xf bank_mask:0xf
    s_waitcnt vmcnt(28)
    v_mfma_f32_16x16x32_bf16 v[72:75], v[208:211], v[16:19], 0
    v_mfma_f32_16x16x32_bf16 v[72:75], v[212:215], v[20:23], v[72:75]
    v_mfma_f32_16x16x32_bf16 v[76:79], v[216:219], v[16:19], 0
    v_mfma_f32_16x16x32_bf16 v[76:79], v[220:223], v[20:23], v[76:79]
    buffer_load_dwordx4 v[208:211], v4, s[36:39], s50 offen offset:0 nt
    buffer_load_dwordx4 v[212:215], v4, s[36:39], s50 offen offset:256 nt
    buffer_load_dwordx4 v[216:219], v4, s[36:39], s50 offen offset:512 nt
    buffer_load_dwordx4 v[220:223], v4, s[36:39], s50 offen offset:768 nt
    v_permlane32_swap_b32 v80, v84
    v_permlane32_swap_b32 v81, v85
    v_permlane32_swap_b32 v82, v86
    v_permlane32_swap_b32 v83, v87
    s_nop 0
    v_add_f32_dpp v56, v84, v80 quad_perm:[1,0,3,2] row_mask:0xf bank_mask:0xf
    v_add_f32_dpp v57, v85, v81 quad_perm:[1,0,3,2] row_mask:0xf bank_mask:0xf
    v_add_f32_dpp v58, v86, v82 quad_perm:[1,0,3,2] row_mask:0xf bank_mask:0xf
    v_add_f32_dpp v59, v87, v83 quad_perm:[1,0,3,2] row_mask:0xf bank_mask:0xf
    s_waitcnt vmcnt(28)
    v_mfma_f32_16x16x32_bf16 v[80:83], v[224:227], v[16:19], 0
    v_mfma_f32_16x16x32_bf16 v[80:83], v[228:231], v[20:23], v[80:83]
    v_mfma_f32_16x16x32_bf16 v[84:87], v[232:235], v[16:19], 0
    v_mfma_f32_16x16x32_bf16 v[84:87], v[236:239], v[20:23], v[84:87]
    buffer_load_dwordx4 v[224:227], v4, s[36:39], s51 offen offset:0 nt
    buffer_load_dwordx4 v[228:231], v4, s[36:39], s51 offen offset:256 nt
    buffer_load_dwordx4 v[232:235], v4, s[36:39], s51 offen offset:512 nt
    buffer_load_dwordx4 v[236:239], v4, s[36:39], s51 offen offset:768 nt
    v_permlane32_swap_b32 v72, v76
    v_permlane32_swap_b32 v73, v77
    v_permlane32_swap_b32 v74, v78
    v_permlane32_swap_b32 v75, v79
    s_nop 0
    v_add_f32_dpp v60, v76, v72 quad_perm:[1,0,3,2] row_mask:0xf bank_mask:0xf
    v_add_f32_dpp v61, v77, v73 quad_perm:[1,0,3,2] row_mask:0xf bank_mask:0xf
    v_add_f32_dpp v62, v78, v74 quad_perm:[1,0,3,2] row_mask:0xf bank_mask:0xf
    v_add_f32_dpp v63, v79, v75 quad_perm:[1,0,3,2] row_mask:0xf bank_mask:0xf
    s_nop 0
    v_permlane32_swap_b32 v80, v84
    v_permlane32_swap_b32 v81, v85
    v_permlane32_swap_b32 v82, v86
    v_permlane32_swap_b32 v83, v87
    s_nop 0
    v_add_f32_dpp v64, v84, v80 quad_perm:[1,0,3,2] row_mask:0xf bank_mask:0xf
    v_add_f32_dpp v65, v85, v81 quad_perm:[1,0,3,2] row_mask:0xf bank_mask:0xf
    v_add_f32_dpp v66, v86, v82 quad_perm:[1,0,3,2] row_mask:0xf bank_mask:0xf
    v_add_f32_dpp v67, v87, v83 quad_perm:[1,0,3,2] row_mask:0xf bank_mask:0xf
    v_max3_f32 v10, v36, v37, v38
    v_max3_f32 v10, v10, v39, v40
    v_max3_f32 v10, v10, v41, v42
    v_max3_f32 v10, v10, v43, v44
    v_max3_f32 v10, v10, v45, v46
    v_max3_f32 v10, v10, v47, v48
    v_max3_f32 v10, v10, v49, v50
    v_max3_f32 v10, v10, v51, v52
    v_max3_f32 v10, v10, v53, v54
    v_max3_f32 v10, v10, v55, v56
    v_max3_f32 v10, v10, v57, v58
    v_max3_f32 v10, v10, v59, v60
    v_max3_f32 v10, v10, v61, v62
    v_max3_f32 v10, v10, v63, v64
    v_max3_f32 v10, v10, v65, v66
    v_max_f32 v10, v10, v67
    v_mov_b32 v5, v10
    s_nop 1
    v_permlane16_swap_b32 v10, v5
    v_max_f32 v10, v10, v5
    v_mov_b32 v5, v10
    s_nop 1
    v_permlane32_swap_b32 v10, v5
    v_max_f32 v10, v10, v5
    v_mul_f32 v10, s71, v10
    v_fma_f32 v36, v36, s71, -v10
    v_fma_f32 v37, v37, s71, -v10
    v_fma_f32 v38, v38, s71, -v10
    v_fma_f32 v39, v39, s71, -v10
    v_fma_f32 v40, v40, s71, -v10
    v_fma_f32 v41, v41, s71, -v10
    v_fma_f32 v42, v42, s71, -v10
    v_fma_f32 v43, v43, s71, -v10
    v_fma_f32 v44, v44, s71, -v10
    v_fma_f32 v45, v45, s71, -v10
    v_fma_f32 v46, v46, s71, -v10
    v_fma_f32 v47, v47, s71, -v10
    v_fma_f32 v48, v48, s71, -v10
    v_fma_f32 v49, v49, s71, -v10
    v_fma_f32 v50, v50, s71, -v10
    v_fma_f32 v51, v51, s71, -v10
    v_fma_f32 v52, v52, s71, -v10
    v_fma_f32 v53, v53, s71, -v10
    v_fma_f32 v54, v54, s71, -v10
    v_fma_f32 v55, v55, s71, -v10
    v_fma_f32 v56, v56, s71, -v10
    v_fma_f32 v57, v57, s71, -v10
    v_fma_f32 v58, v58, s71, -v10
    v_fma_f32 v59, v59, s71, -v10
    v_fma_f32 v60, v60, s71, -v10
    v_fma_f32 v61, v61, s71, -v10
    v_fma_f32 v62, v62, s71, -v10
    v_fma_f32 v63, v63, s71, -v10
    v_fma_f32 v64, v64, s71, -v10
    v_fma_f32 v65, v65, s71, -v10
    v_fma_f32 v66, v66, s71, -v10
    v_fma_f32 v67, v67, s71, -v10
    v_exp_f32 v36, v36
    v_exp_f32 v37, v37
    v_exp_f32 v38, v38
    v_exp_f32 v39, v39
    v_exp_f32 v40, v40
    v_exp_f32 v41, v41
    v_exp_f32 v42, v42
    v_exp_f32 v43, v43
    v_exp_f32 v44, v44
    v_exp_f32 v45, v45
    v_exp_f32 v46, v46
    v_exp_f32 v47, v47
    v_exp_f32 v48, v48
    v_exp_f32 v49, v49
    v_exp_f32 v50, v50
    v_exp_f32 v51, v51
    v_exp_f32 v52, v52
    v_exp_f32 v53, v53
    v_exp_f32 v54, v54
    v_exp_f32 v55, v55
    v_exp_f32 v56, v56
    v_exp_f32 v57, v57
    v_exp_f32 v58, v58
    v_exp_f32 v59, v59
    v_exp_f32 v60, v60
    v_exp_f32 v61, v61
    v_exp_f32 v62, v62
    v_exp_f32 v63, v63
    v_exp_f32 v64, v64
    v_exp_f32 v65, v65
    v_exp_f32 v66, v66
    v_exp_f32 v67, v67
    s_mov_b64 exec, s[56:57]
    ds_write_b32 v11, v10 offset:17408
    s_mov_b64 exec, -1
    v_cvt_pk_bf16_f32 v16, v36, v37
    v_cvt_pk_bf16_f32 v17, v38, v39
    v_cvt_pk_bf16_f32 v18, v40, v41
    v_cvt_pk_bf16_f32 v19, v42, v43
    v_cvt_pk_bf16_f32 v20, v44, v45
    v_cvt_pk_bf16_f32 v21, v46, v47
    v_cvt_pk_bf16_f32 v22, v48, v49
    v_cvt_pk_bf16_f32 v23, v50, v51
    v_cvt_pk_bf16_f32 v24, v52, v53
    v_cvt_pk_bf16_f32 v25, v54, v55
    v_cvt_pk_bf16_f32 v26, v56, v57
    v_cvt_pk_bf16_f32 v27, v58, v59
    v_cvt_pk_bf16_f32 v28, v60, v61
    v_cvt_pk_bf16_f32 v29, v62, v63
    v_cvt_pk_bf16_f32 v30, v64, v65
    v_cvt_pk_bf16_f32 v31, v66, v67
    s_nop 1
    v_mfma_f32_16x16x32_bf16 v[104:107], v[16:19], v[108:111], 0
    v_mfma_f32_16x16x32_bf16 v[104:107], v[20:23], v[108:111], v[104:107]
    v_mfma_f32_16x16x32_bf16 v[104:107], v[24:27], v[108:111], v[104:107]
    v_mfma_f32_16x16x32_bf16 v[104:107], v[28:31], v[108:111], v[104:107]
    v_mov_b32 v5, 1
    s_nop 6
    ds_write_b32 v14, v104 offset:17412
    s_mov_b64 exec, 1
    ds_add_u32 v13, v5 offset:17796
    s_mov_b64 exec, -1
    s_waitcnt vmcnt(30)
    v_perm_b32 v36, v116, v112, s30
    v_perm_b32 v40, v116, v112, s31
    v_perm_b32 v44, v117, v113, s30
    v_perm_b32 v48, v117, v113, s31
    v_perm_b32 v52, v118, v114, s30
    v_perm_b32 v56, v118, v114, s31
    v_perm_b32 v60, v119, v115, s30
    v_perm_b32 v64, v119, v115, s31
    s_waitcnt vmcnt(28)
    v_perm_b32 v37, v124, v120, s30
    v_perm_b32 v41, v124, v120, s31
    v_perm_b32 v45, v125, v121, s30
    v_perm_b32 v49, v125, v121, s31
    v_perm_b32 v53, v126, v122, s30
    v_perm_b32 v57, v126, v122, s31
    v_perm_b32 v61, v127, v123, s30
    v_perm_b32 v65, v127, v123, s31
    s_waitcnt vmcnt(26)
    v_perm_b32 v38, v132, v128, s30
    v_perm_b32 v42, v132, v128, s31
    v_perm_b32 v46, v133, v129, s30
    v_perm_b32 v50, v133, v129, s31
    v_perm_b32 v54, v134, v130, s30
    v_perm_b32 v58, v134, v130, s31
    v_perm_b32 v62, v135, v131, s30
    v_perm_b32 v66, v135, v131, s31
    s_waitcnt vmcnt(24)
    v_perm_b32 v39, v140, v136, s30
    v_perm_b32 v43, v140, v136, s31
    v_perm_b32 v47, v141, v137, s30
    v_mfma_f32_16x16x32_bf16 v[72:75], v[16:19], v[36:39], 0
    v_perm_b32 v51, v141, v137, s31
    v_mfma_f32_16x16x32_bf16 v[76:79], v[16:19], v[40:43], 0
    v_perm_b32 v55, v142, v138, s30
    v_mfma_f32_16x16x32_bf16 v[80:83], v[16:19], v[44:47], 0
    v_perm_b32 v59, v142, v138, s31
    v_mfma_f32_16x16x32_bf16 v[84:87], v[16:19], v[48:51], 0
    v_perm_b32 v63, v143, v139, s30
    v_mfma_f32_16x16x32_bf16 v[88:91], v[16:19], v[52:55], 0
    v_perm_b32 v67, v143, v139, s31
    v_mfma_f32_16x16x32_bf16 v[92:95], v[16:19], v[56:59], 0
    v_mfma_f32_16x16x32_bf16 v[96:99], v[16:19], v[60:63], 0
    v_mfma_f32_16x16x32_bf16 v[100:103], v[16:19], v[64:67], 0
    s_waitcnt vmcnt(22)
    v_perm_b32 v36, v148, v144, s30
    v_perm_b32 v40, v148, v144, s31
    v_perm_b32 v44, v149, v145, s30
    v_perm_b32 v48, v149, v145, s31
    v_perm_b32 v52, v150, v146, s30
    v_perm_b32 v56, v150, v146, s31
    v_perm_b32 v60, v151, v147, s30
    v_perm_b32 v64, v151, v147, s31
    s_waitcnt vmcnt(20)
    v_perm_b32 v37, v156, v152, s30
    v_perm_b32 v41, v156, v152, s31
    v_perm_b32 v45, v157, v153, s30
    v_perm_b32 v49, v157, v153, s31
    v_perm_b32 v53, v158, v154, s30
    v_perm_b32 v57, v158, v154, s31
    v_perm_b32 v61, v159, v155, s30
    v_perm_b32 v65, v159, v155, s31
    s_waitcnt vmcnt(18)
    v_perm_b32 v38, v164, v160, s30
    v_perm_b32 v42, v164, v160, s31
    v_perm_b32 v46, v165, v161, s30
    v_perm_b32 v50, v165, v161, s31
    v_perm_b32 v54, v166, v162, s30
    v_perm_b32 v58, v166, v162, s31
    v_perm_b32 v62, v167, v163, s30
    v_perm_b32 v66, v167, v163, s31
    s_waitcnt vmcnt(16)
    v_perm_b32 v39, v172, v168, s30
    v_perm_b32 v43, v172, v168, s31
    v_perm_b32 v47, v173, v169, s30
    v_mfma_f32_16x16x32_bf16 v[72:75], v[20:23], v[36:39], v[72:75]
    v_perm_b32 v51, v173, v169, s31
    v_mfma_f32_16x16x32_bf16 v[76:79], v[20:23], v[40:43], v[76:79]
    v_perm_b32 v55, v174, v170, s30
    v_mfma_f32_16x16x32_bf16 v[80:83], v[20:23], v[44:47], v[80:83]
    v_perm_b32 v59, v174, v170, s31
    v_mfma_f32_16x16x32_bf16 v[84:87], v[20:23], v[48:51], v[84:87]
    v_perm_b32 v63, v175, v171, s30
    v_mfma_f32_16x16x32_bf16 v[88:91], v[20:23], v[52:55], v[88:91]
    v_perm_b32 v67, v175, v171, s31
    v_mfma_f32_16x16x32_bf16 v[92:95], v[20:23], v[56:59], v[92:95]
    v_mfma_f32_16x16x32_bf16 v[96:99], v[20:23], v[60:63], v[96:99]
    v_mfma_f32_16x16x32_bf16 v[100:103], v[20:23], v[64:67], v[100:103]
    s_waitcnt vmcnt(14)
    v_perm_b32 v36, v180, v176, s30
    v_perm_b32 v40, v180, v176, s31
    v_perm_b32 v44, v181, v177, s30
    v_perm_b32 v48, v181, v177, s31
    v_perm_b32 v52, v182, v178, s30
    v_perm_b32 v56, v182, v178, s31
    v_perm_b32 v60, v183, v179, s30
    v_perm_b32 v64, v183, v179, s31
    s_waitcnt vmcnt(12)
    v_perm_b32 v37, v188, v184, s30
    v_perm_b32 v41, v188, v184, s31
    v_perm_b32 v45, v189, v185, s30
    v_perm_b32 v49, v189, v185, s31
    v_perm_b32 v53, v190, v186, s30
    v_perm_b32 v57, v190, v186, s31
    v_perm_b32 v61, v191, v187, s30
    v_perm_b32 v65, v191, v187, s31
    s_waitcnt vmcnt(10)
    v_perm_b32 v38, v196, v192, s30
    v_perm_b32 v42, v196, v192, s31
    v_perm_b32 v46, v197, v193, s30
    v_perm_b32 v50, v197, v193, s31
    v_perm_b32 v54, v198, v194, s30
    v_perm_b32 v58, v198, v194, s31
    v_perm_b32 v62, v199, v195, s30
    v_perm_b32 v66, v199, v195, s31
    s_waitcnt vmcnt(8)
    v_perm_b32 v39, v204, v200, s30
    v_perm_b32 v43, v204, v200, s31
    v_perm_b32 v47, v205, v201, s30
    v_mfma_f32_16x16x32_bf16 v[72:75], v[24:27], v[36:39], v[72:75]
    v_perm_b32 v51, v205, v201, s31
    v_mfma_f32_16x16x32_bf16 v[76:79], v[24:27], v[40:43], v[76:79]
    v_perm_b32 v55, v206, v202, s30
    v_mfma_f32_16x16x32_bf16 v[80:83], v[24:27], v[44:47], v[80:83]
    v_perm_b32 v59, v206, v202, s31
    v_mfma_f32_16x16x32_bf16 v[84:87], v[24:27], v[48:51], v[84:87]
    v_perm_b32 v63, v207, v203, s30
    v_mfma_f32_16x16x32_bf16 v[88:91], v[24:27], v[52:55], v[88:91]
    v_perm_b32 v67, v207, v203, s31
    v_mfma_f32_16x16x32_bf16 v[92:95], v[24:27], v[56:59], v[92:95]
    v_mfma_f32_16x16x32_bf16 v[96:99], v[24:27], v[60:63], v[96:99]
    v_mfma_f32_16x16x32_bf16 v[100:103], v[24:27], v[64:67], v[100:103]
    s_waitcnt vmcnt(6)
    v_perm_b32 v36, v212, v208, s30
    v_perm_b32 v40, v212, v208, s31
    v_perm_b32 v44, v213, v209, s30
    v_perm_b32 v48, v213, v209, s31
    v_perm_b32 v52, v214, v210, s30
    v_perm_b32 v56, v214, v210, s31
    v_perm_b32 v60, v215, v211, s30
    v_perm_b32 v64, v215, v211, s31
    s_waitcnt vmcnt(4)
    v_perm_b32 v37, v220, v216, s30
    v_perm_b32 v41, v220, v216, s31
    v_perm_b32 v45, v221, v217, s30
    v_perm_b32 v49, v221, v217, s31
    v_perm_b32 v53, v222, v218, s30
    v_perm_b32 v57, v222, v218, s31
    v_perm_b32 v61, v223, v219, s30
    v_perm_b32 v65, v223, v219, s31
    s_waitcnt vmcnt(2)
    v_perm_b32 v38, v228, v224, s30
    v_perm_b32 v42, v228, v224, s31
    v_perm_b32 v46, v229, v225, s30
    v_perm_b32 v50, v229, v225, s31
    v_perm_b32 v54, v230, v226, s30
    v_perm_b32 v58, v230, v226, s31
    v_perm_b32 v62, v231, v227, s30
    v_perm_b32 v66, v231, v227, s31
    s_waitcnt vmcnt(0)
    v_perm_b32 v39, v236, v232, s30
    v_perm_b32 v43, v236, v232, s31
    v_perm_b32 v47, v237, v233, s30
    v_mfma_f32_16x16x32_bf16 v[72:75], v[28:31], v[36:39], v[72:75]
    v_perm_b32 v51, v237, v233, s31
    v_mfma_f32_16x16x32_bf16 v[76:79], v[28:31], v[40:43], v[76:79]
    v_perm_b32 v55, v238, v234, s30
    v_mfma_f32_16x16x32_bf16 v[80:83], v[28:31], v[44:47], v[80:83]
    v_perm_b32 v59, v238, v234, s31
    v_mfma_f32_16x16x32_bf16 v[84:87], v[28:31], v[48:51], v[84:87]
    v_perm_b32 v63, v239, v235, s30
    v_mfma_f32_16x16x32_bf16 v[88:91], v[28:31], v[52:55], v[88:91]
    v_perm_b32 v67, v239, v235, s31
    v_mfma_f32_16x16x32_bf16 v[92:95], v[28:31], v[56:59], v[92:95]
    v_mfma_f32_16x16x32_bf16 v[96:99], v[28:31], v[60:63], v[96:99]
    v_mfma_f32_16x16x32_bf16 v[100:103], v[28:31], v[64:67], v[100:103]
    s_branch L_pvdone
L_body9:
    buffer_load_dwordx4 v[224:227], v3, s[32:35], s51 offen offset:0 nt
    buffer_load_dwordx4 v[228:231], v3, s[32:35], s51 offen offset:128 nt
    buffer_load_dwordx4 v[232:235], v3, s[32:35], s51 offen offset:2048 nt
    buffer_load_dwordx4 v[236:239], v3, s[32:35], s51 offen offset:2176 nt
    buffer_load_dwordx4 v[240:243], v3, s[32:35], s52 offen offset:0 nt
    buffer_load_dwordx4 v[244:247], v3, s[32:35], s52 offen offset:128 nt
    buffer_load_dwordx4 v[248:251], v3, s[32:35], s52 offen offset:2048 nt
    buffer_load_dwordx4 v[252:255], v3, s[32:35], s52 offen offset:2176 nt
    s_waitcnt lgkmcnt(0)
    s_waitcnt vmcnt(32)
    v_mfma_f32_16x16x32_bf16 v[72:75], v[112:115], v[16:19], 0
    v_mfma_f32_16x16x32_bf16 v[72:75], v[116:119], v[20:23], v[72:75]
    v_mfma_f32_16x16x32_bf16 v[76:79], v[120:123], v[16:19], 0
    v_mfma_f32_16x16x32_bf16 v[76:79], v[124:127], v[20:23], v[76:79]
    buffer_load_dwordx4 v[112:115], v4, s[36:39], s44 offen offset:0 nt
    buffer_load_dwordx4 v[116:119], v4, s[36:39], s44 offen offset:256 nt
    buffer_load_dwordx4 v[120:123], v4, s[36:39], s44 offen offset:512 nt
    buffer_load_dwordx4 v[124:127], v4, s[36:39], s44 offen offset:768 nt
    s_waitcnt vmcnt(32)
    v_mfma_f32_16x16x32_bf16 v[80:83], v[128:131], v[16:19], 0
    v_mfma_f32_16x16x32_bf16 v[80:83], v[132:135], v[20:23], v[80:83]
    v_mfma_f32_16x16x32_bf16 v[84:87], v[136:139], v[16:19], 0
    v_mfma_f32_16x16x32_bf16 v[84:87], v[140:143], v[20:23], v[84:87]
    buffer_load_dwordx4 v[128:131], v4, s[36:39], s45 offen offset:0 nt
    buffer_load_dwordx4 v[132:135], v4, s[36:39], s45 offen offset:256 nt
    buffer_load_dwordx4 v[136:139], v4, s[36:39], s45 offen offset:512 nt
    buffer_load_dwordx4 v[140:143], v4, s[36:39], s45 offen offset:768 nt
    v_permlane32_swap_b32 v72, v76
    v_permlane32_swap_b32 v73, v77
    v_permlane32_swap_b32 v74, v78
    v_permlane32_swap_b32 v75, v79
    s_nop 0
    v_add_f32_dpp v36, v76, v72 quad_perm:[1,0,3,2] row_mask:0xf bank_mask:0xf
    v_add_f32_dpp v37, v77, v73 quad_perm:[1,0,3,2] row_mask:0xf bank_mask:0xf
    v_add_f32_dpp v38, v78, v74 quad_perm:[1,0,3,2] row_mask:0xf bank_mask:0xf
    v_add_f32_dpp v39, v79, v75 quad_perm:[1,0,3,2] row_mask:0xf bank_mask:0xf
    s_waitcnt vmcnt(32)
    v_mfma_f32_16x16x32_bf16 v[72:75], v[144:147], v[16:19], 0
    v_mfma_f32_16x16x32_bf16 v[72:75], v[148:151], v[20:23], v[72:75]
    v_mfma_f32_16x16x32_bf16 v[76:79], v[152:155], v[16:19], 0
    v_mfma_f32_16x16x32_bf16 v[76:79], v[156:159], v[20:23], v[76:79]
    buffer_load_dwordx4 v[144:147], v4, s[36:39], s46 offen offset:0 nt
    buffer_load_dwordx4 v[148:151], v4, s[36:39], s46 offen offset:256 nt
    buffer_load_dwordx4 v[152:155], v4, s[36:39], s46 offen offset:512 nt
    buffer_load_dwordx4 v[156:159], v4, s[36:39], s46 offen offset:768 nt
    v_permlane32_swap_b32 v80, v84
    v_permlane32_swap_b32 v81, v85
    v_permlane32_swap_b32 v82, v86
    v_permlane32_swap_b32 v83, v87
    s_nop 0
    v_add_f32_dpp v40, v84, v80 quad_perm:[1,0,3,2] row_mask:0xf bank_mask:0xf
    v_add_f32_dpp v41, v85, v81 quad_perm:[1,0,3,2] row_mask:0xf bank_mask:0xf
    v_add_f32_dpp v42, v86, v82 quad_perm:[1,0,3,2] row_mask:0xf bank_mask:0xf
    v_add_f32_dpp v43, v87, v83 quad_perm:[1,0,3,2] row_mask:0xf bank_mask:0xf
    s_waitcnt vmcnt(32)
    v_mfma_f32_16x16x32_bf16 v[80:83], v[160:163], v[16:19], 0
    v_mfma_f32_16x16x32_bf16 v[80:83], v[164:167], v[20:23], v[80:83]
    v_mfma_f32_16x16x32_bf16 v[84:87], v[168:171], v[16:19], 0
    v_mfma_f32_16x16x32_bf16 v[84:87], v[172:175], v[20:23], v[84:87]
    buffer_load_dwordx4 v[160:163], v4, s[36:39], s47 offen offset:0 nt
    buffer_load_dwordx4 v[164:167], v4, s[36:39], s47 offen offset:256 nt
    buffer_load_dwordx4 v[168:171], v4, s[36:39], s47 offen offset:512 nt
    buffer_load_dwordx4 v[172:175], v4, s[36:39], s47 offen offset:768 nt
    v_permlane32_swap_b32 v72, v76
    v_permlane32_swap_b32 v73, v77
    v_permlane32_swap_b32 v74, v78
    v_permlane32_swap_b32 v75, v79
    s_nop 0
    v_add_f32_dpp v44, v76, v72 quad_perm:[1,0,3,2] row_mask:0xf bank_mask:0xf
    v_add_f32_dpp v45, v77, v73 quad_perm:[1,0,3,2] row_mask:0xf bank_mask:0xf
    v_add_f32_dpp v46, v78, v74 quad_perm:[1,0,3,2] row_mask:0xf bank_mask:0xf
    v_add_f32_dpp v47, v79, v75 quad_perm:[1,0,3,2] row_mask:0xf bank_mask:0xf
    s_waitcnt vmcnt(32)
    v_mfma_f32_16x16x32_bf16 v[72:75], v[176:179], v[16:19], 0
    v_mfma_f32_16x16x32_bf16 v[72:75], v[180:183], v[20:23], v[72:75]
    v_mfma_f32_16x16x32_bf16 v[76:79], v[184:187], v[16:19], 0
    v_mfma_f32_16x16x32_bf16 v[76:79], v[188:191], v[20:23], v[76:79]
    buffer_load_dwordx4 v[176:179], v4, s[36:39], s48 offen offset:0 nt
    buffer_load_dwordx4 v[180:183], v4, s[36:39], s48 offen offset:256 nt
    buffer_load_dwordx4 v[184:187], v4, s[36:39], s48 offen offset:512 nt
    buffer_load_dwordx4 v[188:191], v4, s[36:39], s48 offen offset:768 nt
    v_permlane32_swap_b32 v80, v84
    v_permlane32_swap_b32 v81, v85
    v_permlane32_swap_b32 v82, v86
    v_permlane32_swap_b32 v83, v87
    s_nop 0
    v_add_f32_dpp v48, v84, v80 quad_perm:[1,0,3,2] row_mask:0xf bank_mask:0xf
    v_add_f32_dpp v49, v85, v81 quad_perm:[1,0,3,2] row_mask:0xf bank_mask:0xf
    v_add_f32_dpp v50, v86, v82 quad_perm:[1,0,3,2] row_mask:0xf bank_mask:0xf
    v_add_f32_dpp v51, v87, v83 quad_perm:[1,0,3,2] row_mask:0xf bank_mask:0xf
    s_waitcnt vmcnt(32)
    v_mfma_f32_16x16x32_bf16 v[80:83], v[192:195], v[16:19], 0
    v_mfma_f32_16x16x32_bf16 v[80:83], v[196:199], v[20:23], v[80:83]
    v_mfma_f32_16x16x32_bf16 v[84:87], v[200:203], v[16:19], 0
    v_mfma_f32_16x16x32_bf16 v[84:87], v[204:207], v[20:23], v[84:87]
    buffer_load_dwordx4 v[192:195], v4, s[36:39], s49 offen offset:0 nt
    buffer_load_dwordx4 v[196:199], v4, s[36:39], s49 offen offset:256 nt
    buffer_load_dwordx4 v[200:203], v4, s[36:39], s49 offen offset:512 nt
    buffer_load_dwordx4 v[204:207], v4, s[36:39], s49 offen offset:768 nt
    v_permlane32_swap_b32 v72, v76
    v_permlane32_swap_b32 v73, v77
    v_permlane32_swap_b32 v74, v78
    v_permlane32_swap_b32 v75, v79
    s_nop 0
    v_add_f32_dpp v52, v76, v72 quad_perm:[1,0,3,2] row_mask:0xf bank_mask:0xf
    v_add_f32_dpp v53, v77, v73 quad_perm:[1,0,3,2] row_mask:0xf bank_mask:0xf
    v_add_f32_dpp v54, v78, v74 quad_perm:[1,0,3,2] row_mask:0xf bank_mask:0xf
    v_add_f32_dpp v55, v79, v75 quad_perm:[1,0,3,2] row_mask:0xf bank_mask:0xf
    s_waitcnt vmcnt(32)
    v_mfma_f32_16x16x32_bf16 v[72:75], v[208:211], v[16:19], 0
    v_mfma_f32_16x16x32_bf16 v[72:75], v[212:215], v[20:23], v[72:75]
    v_mfma_f32_16x16x32_bf16 v[76:79], v[216:219], v[16:19], 0
    v_mfma_f32_16x16x32_bf16 v[76:79], v[220:223], v[20:23], v[76:79]
    buffer_load_dwordx4 v[208:211], v4, s[36:39], s50 offen offset:0 nt
    buffer_load_dwordx4 v[212:215], v4, s[36:39], s50 offen offset:256 nt
    buffer_load_dwordx4 v[216:219], v4, s[36:39], s50 offen offset:512 nt
    buffer_load_dwordx4 v[220:223], v4, s[36:39], s50 offen offset:768 nt
    v_permlane32_swap_b32 v80, v84
    v_permlane32_swap_b32 v81, v85
    v_permlane32_swap_b32 v82, v86
    v_permlane32_swap_b32 v83, v87
    s_nop 0
    v_add_f32_dpp v56, v84, v80 quad_perm:[1,0,3,2] row_mask:0xf bank_mask:0xf
    v_add_f32_dpp v57, v85, v81 quad_perm:[1,0,3,2] row_mask:0xf bank_mask:0xf
    v_add_f32_dpp v58, v86, v82 quad_perm:[1,0,3,2] row_mask:0xf bank_mask:0xf
    v_add_f32_dpp v59, v87, v83 quad_perm:[1,0,3,2] row_mask:0xf bank_mask:0xf
    s_waitcnt vmcnt(32)
    v_mfma_f32_16x16x32_bf16 v[80:83], v[224:227], v[16:19], 0
    v_mfma_f32_16x16x32_bf16 v[80:83], v[228:231], v[20:23], v[80:83]
    v_mfma_f32_16x16x32_bf16 v[84:87], v[232:235], v[16:19], 0
    v_mfma_f32_16x16x32_bf16 v[84:87], v[236:239], v[20:23], v[84:87]
    buffer_load_dwordx4 v[224:227], v4, s[36:39], s51 offen offset:0 nt
    buffer_load_dwordx4 v[228:231], v4, s[36:39], s51 offen offset:256 nt
    buffer_load_dwordx4 v[232:235], v4, s[36:39], s51 offen offset:512 nt
    buffer_load_dwordx4 v[236:239], v4, s[36:39], s51 offen offset:768 nt
    v_permlane32_swap_b32 v72, v76
    v_permlane32_swap_b32 v73, v77
    v_permlane32_swap_b32 v74, v78
    v_permlane32_swap_b32 v75, v79
    s_nop 0
    v_add_f32_dpp v60, v76, v72 quad_perm:[1,0,3,2] row_mask:0xf bank_mask:0xf
    v_add_f32_dpp v61, v77, v73 quad_perm:[1,0,3,2] row_mask:0xf bank_mask:0xf
    v_add_f32_dpp v62, v78, v74 quad_perm:[1,0,3,2] row_mask:0xf bank_mask:0xf
    v_add_f32_dpp v63, v79, v75 quad_perm:[1,0,3,2] row_mask:0xf bank_mask:0xf
    s_waitcnt vmcnt(32)
    v_mfma_f32_16x16x32_bf16 v[72:75], v[240:243], v[16:19], 0
    v_mfma_f32_16x16x32_bf16 v[72:75], v[244:247], v[20:23], v[72:75]
    v_mfma_f32_16x16x32_bf16 v[76:79], v[248:251], v[16:19], 0
    v_mfma_f32_16x16x32_bf16 v[76:79], v[252:255], v[20:23], v[76:79]
    buffer_load_dwordx4 v[240:243], v4, s[36:39], s52 offen offset:0 nt
    buffer_load_dwordx4 v[244:247], v4, s[36:39], s52 offen offset:256 nt
    buffer_load_dwordx4 v[248:251], v4, s[36:39], s52 offen offset:512 nt
    buffer_load_dwordx4 v[252:255], v4, s[36:39], s52 offen offset:768 nt
    v_permlane32_swap_b32 v80, v84
    v_permlane32_swap_b32 v81, v85
    v_permlane32_swap_b32 v82, v86
    v_permlane32_swap_b32 v83, v87
    s_nop 0
    v_add_f32_dpp v64, v84, v80 quad_perm:[1,0,3,2] row_mask:0xf bank_mask:0xf
    v_add_f32_dpp v65, v85, v81 quad_perm:[1,0,3,2] row_mask:0xf bank_mask:0xf
    v_add_f32_dpp v66, v86, v82 quad_perm:[1,0,3,2] row_mask:0xf bank_mask:0xf
    v_add_f32_dpp v67, v87, v83 quad_perm:[1,0,3,2] row_mask:0xf bank_mask:0xf
    s_nop 0
    v_permlane32_swap_b32 v72, v76
    v_permlane32_swap_b32 v73, v77
    v_permlane32_swap_b32 v74, v78
    v_permlane32_swap_b32 v75, v79
    s_nop 0
    v_add_f32_dpp v68, v76, v72 quad_perm:[1,0,3,2] row_mask:0xf bank_mask:0xf
    v_add_f32_dpp v69, v77, v73 quad_perm:[1,0,3,2] row_mask:0xf bank_mask:0xf
    v_add_f32_dpp v70, v78, v74 quad_perm:[1,0,3,2] row_mask:0xf bank_mask:0xf
    v_add_f32_dpp v71, v79, v75 quad_perm:[1,0,3,2] row_mask:0xf bank_mask:0xf
    v_max3_f32 v10, v36, v37, v38
    v_max3_f32 v10, v10, v39, v40
    v_max3_f32 v10, v10, v41, v42
    v_max3_f32 v10, v10, v43, v44
    v_max3_f32 v10, v10, v45, v46
    v_max3_f32 v10, v10, v47, v48
    v_max3_f32 v10, v10, v49, v50
    v_max3_f32 v10, v10, v51, v52
    v_max3_f32 v10, v10, v53, v54
    v_max3_f32 v10, v10, v55, v56
    v_max3_f32 v10, v10, v57, v58
    v_max3_f32 v10, v10, v59, v60
    v_max3_f32 v10, v10, v61, v62
    v_max3_f32 v10, v10, v63, v64
    v_max3_f32 v10, v10, v65, v66
    v_max3_f32 v10, v10, v67, v68
    v_max3_f32 v10, v10, v69, v70
    v_max_f32 v10, v10, v71
    v_mov_b32 v5, v10
    s_nop 1
    v_permlane16_swap_b32 v10, v5
    v_max_f32 v10, v10, v5
    v_mov_b32 v5, v10
    s_nop 1
    v_permlane32_swap_b32 v10, v5
    v_max_f32 v10, v10, v5
    v_mul_f32 v10, s71, v10
    v_fma_f32 v36, v36, s71, -v10
    v_fma_f32 v37, v37, s71, -v10
    v_fma_f32 v38, v38, s71, -v10
    v_fma_f32 v39, v39, s71, -v10
    v_fma_f32 v40, v40, s71, -v10
    v_fma_f32 v41, v41, s71, -v10
    v_fma_f32 v42, v42, s71, -v10
    v_fma_f32 v43, v43, s71, -v10
    v_fma_f32 v44, v44, s71, -v10
    v_fma_f32 v45, v45, s71, -v10
    v_fma_f32 v46, v46, s71, -v10
    v_fma_f32 v47, v47, s71, -v10
    v_fma_f32 v48, v48, s71, -v10
    v_fma_f32 v49, v49, s71, -v10
    v_fma_f32 v50, v50, s71, -v10
    v_fma_f32 v51, v51, s71, -v10
    v_fma_f32 v52, v52, s71, -v10
    v_fma_f32 v53, v53, s71, -v10
    v_fma_f32 v54, v54, s71, -v10
    v_fma_f32 v55, v55, s71, -v10
    v_fma_f32 v56, v56, s71, -v10
    v_fma_f32 v57, v57, s71, -v10
    v_fma_f32 v58, v58, s71, -v10
    v_fma_f32 v59, v59, s71, -v10
    v_fma_f32 v60, v60, s71, -v10
    v_fma_f32 v61, v61, s71, -v10
    v_fma_f32 v62, v62, s71, -v10
    v_fma_f32 v63, v63, s71, -v10
    v_fma_f32 v64, v64, s71, -v10
    v_fma_f32 v65, v65, s71, -v10
    v_fma_f32 v66, v66, s71, -v10
    v_fma_f32 v67, v67, s71, -v10
    v_fma_f32 v68, v68, s71, -v10
    v_fma_f32 v69, v69, s71, -v10
    v_fma_f32 v70, v70, s71, -v10
    v_fma_f32 v71, v71, s71, -v10
    v_exp_f32 v36, v36
    v_exp_f32 v37, v37
    v_exp_f32 v38, v38
    v_exp_f32 v39, v39
    v_exp_f32 v40, v40
    v_exp_f32 v41, v41
    v_exp_f32 v42, v42
    v_exp_f32 v43, v43
    v_exp_f32 v44, v44
    v_exp_f32 v45, v45
    v_exp_f32 v46, v46
    v_exp_f32 v47, v47
    v_exp_f32 v48, v48
    v_exp_f32 v49, v49
    v_exp_f32 v50, v50
    v_exp_f32 v51, v51
    v_exp_f32 v52, v52
    v_exp_f32 v53, v53
    v_exp_f32 v54, v54
    v_exp_f32 v55, v55
    v_exp_f32 v56, v56
    v_exp_f32 v57, v57
    v_exp_f32 v58, v58
    v_exp_f32 v59, v59
    v_exp_f32 v60, v60
    v_exp_f32 v61, v61
    v_exp_f32 v62, v62
    v_exp_f32 v63, v63
    v_exp_f32 v64, v64
    v_exp_f32 v65, v65
    v_exp_f32 v66, v66
    v_exp_f32 v67, v67
    v_exp_f32 v68, v68
    v_exp_f32 v69, v69
    v_exp_f32 v70, v70
    v_exp_f32 v71, v71
    s_mov_b64 exec, s[56:57]
    ds_write_b32 v11, v10 offset:17408
    s_mov_b64 exec, -1
    v_cvt_pk_bf16_f32 v16, v36, v37
    v_cvt_pk_bf16_f32 v17, v38, v39
    v_cvt_pk_bf16_f32 v18, v40, v41
    v_cvt_pk_bf16_f32 v19, v42, v43
    v_cvt_pk_bf16_f32 v20, v44, v45
    v_cvt_pk_bf16_f32 v21, v46, v47
    v_cvt_pk_bf16_f32 v22, v48, v49
    v_cvt_pk_bf16_f32 v23, v50, v51
    v_cvt_pk_bf16_f32 v24, v52, v53
    v_cvt_pk_bf16_f32 v25, v54, v55
    v_cvt_pk_bf16_f32 v26, v56, v57
    v_cvt_pk_bf16_f32 v27, v58, v59
    v_cvt_pk_bf16_f32 v28, v60, v61
    v_cvt_pk_bf16_f32 v29, v62, v63
    v_cvt_pk_bf16_f32 v30, v64, v65
    v_cvt_pk_bf16_f32 v31, v66, v67
    v_cvt_pk_bf16_f32 v32, v68, v69
    v_cvt_pk_bf16_f32 v33, v70, v71
    s_nop 1
    v_mfma_f32_16x16x32_bf16 v[104:107], v[16:19], v[108:111], 0
    v_mfma_f32_16x16x32_bf16 v[104:107], v[20:23], v[108:111], v[104:107]
    v_mfma_f32_16x16x32_bf16 v[104:107], v[24:27], v[108:111], v[104:107]
    v_mfma_f32_16x16x32_bf16 v[104:107], v[28:31], v[108:111], v[104:107]
    s_nop 5
    v_mfma_f32_16x16x16_bf16 v[104:107], v[32:33], v[108:109], v[104:107]
    v_mov_b32 v5, 1
    s_nop 6
    ds_write_b32 v14, v104 offset:17412
    s_mov_b64 exec, 1
    ds_add_u32 v13, v5 offset:17796
    s_mov_b64 exec, -1
    s_waitcnt vmcnt(34)
    v_perm_b32 v36, v116, v112, s30
    v_perm_b32 v40, v116, v112, s31
    v_perm_b32 v44, v117, v113, s30
    v_perm_b32 v48, v117, v113, s31
    v_perm_b32 v52, v118, v114, s30
    v_perm_b32 v56, v118, v114, s31
    v_perm_b32 v60, v119, v115, s30
    v_perm_b32 v64, v119, v115, s31
    s_waitcnt vmcnt(32)
    v_perm_b32 v37, v124, v120, s30
    v_perm_b32 v41, v124, v120, s31
    v_perm_b32 v45, v125, v121, s30
    v_perm_b32 v49, v125, v121, s31
    v_perm_b32 v53, v126, v122, s30
    v_perm_b32 v57, v126, v122, s31
    v_perm_b32 v61, v127, v123, s30
    v_perm_b32 v65, v127, v123, s31
    s_waitcnt vmcnt(30)
    v_perm_b32 v38, v132, v128, s30
    v_perm_b32 v42, v132, v128, s31
    v_perm_b32 v46, v133, v129, s30
    v_perm_b32 v50, v133, v129, s31
    v_perm_b32 v54, v134, v130, s30
    v_perm_b32 v58, v134, v130, s31
    v_perm_b32 v62, v135, v131, s30
    v_perm_b32 v66, v135, v131, s31
    s_waitcnt vmcnt(28)
    v_perm_b32 v39, v140, v136, s30
    v_perm_b32 v43, v140, v136, s31
    v_perm_b32 v47, v141, v137, s30
    v_mfma_f32_16x16x32_bf16 v[72:75], v[16:19], v[36:39], 0
    v_perm_b32 v51, v141, v137, s31
    v_mfma_f32_16x16x32_bf16 v[76:79], v[16:19], v[40:43], 0
    v_perm_b32 v55, v142, v138, s30
    v_mfma_f32_16x16x32_bf16 v[80:83], v[16:19], v[44:47], 0
    v_perm_b32 v59, v142, v138, s31
    v_mfma_f32_16x16x32_bf16 v[84:87], v[16:19], v[48:51], 0
    v_perm_b32 v63, v143, v139, s30
    v_mfma_f32_16x16x32_bf16 v[88:91], v[16:19], v[52:55], 0
    v_perm_b32 v67, v143, v139, s31
    v_mfma_f32_16x16x32_bf16 v[92:95], v[16:19], v[56:59], 0
    v_mfma_f32_16x16x32_bf16 v[96:99], v[16:19], v[60:63], 0
    v_mfma_f32_16x16x32_bf16 v[100:103], v[16:19], v[64:67], 0
    s_waitcnt vmcnt(26)
    v_perm_b32 v36, v148, v144, s30
    v_perm_b32 v40, v148, v144, s31
    v_perm_b32 v44, v149, v145, s30
    v_perm_b32 v48, v149, v145, s31
    v_perm_b32 v52, v150, v146, s30
    v_perm_b32 v56, v150, v146, s31
    v_perm_b32 v60, v151, v147, s30
    v_perm_b32 v64, v151, v147, s31
    s_waitcnt vmcnt(24)
    v_perm_b32 v37, v156, v152, s30
    v_perm_b32 v41, v156, v152, s31
    v_perm_b32 v45, v157, v153, s30
    v_perm_b32 v49, v157, v153, s31
    v_perm_b32 v53, v158, v154, s30
    v_perm_b32 v57, v158, v154, s31
    v_perm_b32 v61, v159, v155, s30
    v_perm_b32 v65, v159, v155, s31
    s_waitcnt vmcnt(22)
    v_perm_b32 v38, v164, v160, s30
    v_perm_b32 v42, v164, v160, s31
    v_perm_b32 v46, v165, v161, s30
    v_perm_b32 v50, v165, v161, s31
    v_perm_b32 v54, v166, v162, s30
    v_perm_b32 v58, v166, v162, s31
    v_perm_b32 v62, v167, v163, s30
    v_perm_b32 v66, v167, v163, s31
    s_waitcnt vmcnt(20)
    v_perm_b32 v39, v172, v168, s30
    v_perm_b32 v43, v172, v168, s31
    v_perm_b32 v47, v173, v169, s30
    v_mfma_f32_16x16x32_bf16 v[72:75], v[20:23], v[36:39], v[72:75]
    v_perm_b32 v51, v173, v169, s31
    v_mfma_f32_16x16x32_bf16 v[76:79], v[20:23], v[40:43], v[76:79]
    v_perm_b32 v55, v174, v170, s30
    v_mfma_f32_16x16x32_bf16 v[80:83], v[20:23], v[44:47], v[80:83]
    v_perm_b32 v59, v174, v170, s31
    v_mfma_f32_16x16x32_bf16 v[84:87], v[20:23], v[48:51], v[84:87]
    v_perm_b32 v63, v175, v171, s30
    v_mfma_f32_16x16x32_bf16 v[88:91], v[20:23], v[52:55], v[88:91]
    v_perm_b32 v67, v175, v171, s31
    v_mfma_f32_16x16x32_bf16 v[92:95], v[20:23], v[56:59], v[92:95]
    v_mfma_f32_16x16x32_bf16 v[96:99], v[20:23], v[60:63], v[96:99]
    v_mfma_f32_16x16x32_bf16 v[100:103], v[20:23], v[64:67], v[100:103]
    s_waitcnt vmcnt(18)
    v_perm_b32 v36, v180, v176, s30
    v_perm_b32 v40, v180, v176, s31
    v_perm_b32 v44, v181, v177, s30
    v_perm_b32 v48, v181, v177, s31
    v_perm_b32 v52, v182, v178, s30
    v_perm_b32 v56, v182, v178, s31
    v_perm_b32 v60, v183, v179, s30
    v_perm_b32 v64, v183, v179, s31
    s_waitcnt vmcnt(16)
    v_perm_b32 v37, v188, v184, s30
    v_perm_b32 v41, v188, v184, s31
    v_perm_b32 v45, v189, v185, s30
    v_perm_b32 v49, v189, v185, s31
    v_perm_b32 v53, v190, v186, s30
    v_perm_b32 v57, v190, v186, s31
    v_perm_b32 v61, v191, v187, s30
    v_perm_b32 v65, v191, v187, s31
    s_waitcnt vmcnt(14)
    v_perm_b32 v38, v196, v192, s30
    v_perm_b32 v42, v196, v192, s31
    v_perm_b32 v46, v197, v193, s30
    v_perm_b32 v50, v197, v193, s31
    v_perm_b32 v54, v198, v194, s30
    v_perm_b32 v58, v198, v194, s31
    v_perm_b32 v62, v199, v195, s30
    v_perm_b32 v66, v199, v195, s31
    s_waitcnt vmcnt(12)
    v_perm_b32 v39, v204, v200, s30
    v_perm_b32 v43, v204, v200, s31
    v_perm_b32 v47, v205, v201, s30
    v_mfma_f32_16x16x32_bf16 v[72:75], v[24:27], v[36:39], v[72:75]
    v_perm_b32 v51, v205, v201, s31
    v_mfma_f32_16x16x32_bf16 v[76:79], v[24:27], v[40:43], v[76:79]
    v_perm_b32 v55, v206, v202, s30
    v_mfma_f32_16x16x32_bf16 v[80:83], v[24:27], v[44:47], v[80:83]
    v_perm_b32 v59, v206, v202, s31
    v_mfma_f32_16x16x32_bf16 v[84:87], v[24:27], v[48:51], v[84:87]
    v_perm_b32 v63, v207, v203, s30
    v_mfma_f32_16x16x32_bf16 v[88:91], v[24:27], v[52:55], v[88:91]
    v_perm_b32 v67, v207, v203, s31
    v_mfma_f32_16x16x32_bf16 v[92:95], v[24:27], v[56:59], v[92:95]
    v_mfma_f32_16x16x32_bf16 v[96:99], v[24:27], v[60:63], v[96:99]
    v_mfma_f32_16x16x32_bf16 v[100:103], v[24:27], v[64:67], v[100:103]
    s_waitcnt vmcnt(10)
    v_perm_b32 v36, v212, v208, s30
    v_perm_b32 v40, v212, v208, s31
    v_perm_b32 v44, v213, v209, s30
    v_perm_b32 v48, v213, v209, s31
    v_perm_b32 v52, v214, v210, s30
    v_perm_b32 v56, v214, v210, s31
    v_perm_b32 v60, v215, v211, s30
    v_perm_b32 v64, v215, v211, s31
    s_waitcnt vmcnt(8)
    v_perm_b32 v37, v220, v216, s30
    v_perm_b32 v41, v220, v216, s31
    v_perm_b32 v45, v221, v217, s30
    v_perm_b32 v49, v221, v217, s31
    v_perm_b32 v53, v222, v218, s30
    v_perm_b32 v57, v222, v218, s31
    v_perm_b32 v61, v223, v219, s30
    v_perm_b32 v65, v223, v219, s31
    s_waitcnt vmcnt(6)
    v_perm_b32 v38, v228, v224, s30
    v_perm_b32 v42, v228, v224, s31
    v_perm_b32 v46, v229, v225, s30
    v_perm_b32 v50, v229, v225, s31
    v_perm_b32 v54, v230, v226, s30
    v_perm_b32 v58, v230, v226, s31
    v_perm_b32 v62, v231, v227, s30
    v_perm_b32 v66, v231, v227, s31
    s_waitcnt vmcnt(4)
    v_perm_b32 v39, v236, v232, s30
    v_perm_b32 v43, v236, v232, s31
    v_perm_b32 v47, v237, v233, s30
    v_mfma_f32_16x16x32_bf16 v[72:75], v[28:31], v[36:39], v[72:75]
    v_perm_b32 v51, v237, v233, s31
    v_mfma_f32_16x16x32_bf16 v[76:79], v[28:31], v[40:43], v[76:79]
    v_perm_b32 v55, v238, v234, s30
    v_mfma_f32_16x16x32_bf16 v[80:83], v[28:31], v[44:47], v[80:83]
    v_perm_b32 v59, v238, v234, s31
    v_mfma_f32_16x16x32_bf16 v[84:87], v[28:31], v[48:51], v[84:87]
    v_perm_b32 v63, v239, v235, s30
    v_mfma_f32_16x16x32_bf16 v[88:91], v[28:31], v[52:55], v[88:91]
    v_perm_b32 v67, v239, v235, s31
    v_mfma_f32_16x16x32_bf16 v[92:95], v[28:31], v[56:59], v[92:95]
    v_mfma_f32_16x16x32_bf16 v[96:99], v[28:31], v[60:63], v[96:99]
    v_mfma_f32_16x16x32_bf16 v[100:103], v[28:31], v[64:67], v[100:103]
    s_waitcnt vmcnt(2)
    v_perm_b32 v36, v244, v240, s30
    v_perm_b32 v40, v244, v240, s31
    v_perm_b32 v44, v245, v241, s30
    v_perm_b32 v48, v245, v241, s31
    v_perm_b32 v52, v246, v242, s30
    v_perm_b32 v56, v246, v242, s31
    v_perm_b32 v60, v247, v243, s30
    v_perm_b32 v64, v247, v243, s31
    s_waitcnt vmcnt(0)
    v_perm_b32 v37, v252, v248, s30
    v_perm_b32 v41, v252, v248, s31
    v_perm_b32 v45, v253, v249, s30
    v_mfma_f32_16x16x16_bf16 v[72:75], v[32:33], v[36:37], v[72:75]
    v_perm_b32 v49, v253, v249, s31
    v_mfma_f32_16x16x16_bf16 v[76:79], v[32:33], v[40:41], v[76:79]
    v_perm_b32 v53, v254, v250, s30
    v_mfma_f32_16x16x16_bf16 v[80:83], v[32:33], v[44:45], v[80:83]
    v_perm_b32 v57, v254, v250, s31
    v_mfma_f32_16x16x16_bf16 v[84:87], v[32:33], v[48:49], v[84:87]
    v_perm_b32 v61, v255, v251, s30
    v_mfma_f32_16x16x16_bf16 v[88:91], v[32:33], v[52:53], v[88:91]
    v_perm_b32 v65, v255, v251, s31
    v_mfma_f32_16x16x16_bf16 v[92:95], v[32:33], v[56:57], v[92:95]
    v_mfma_f32_16x16x16_bf16 v[96:99], v[32:33], v[60:61], v[96:99]
    v_mfma_f32_16x16x16_bf16 v[100:103], v[32:33], v[64:65], v[100:103]
    s_branch L_pvdone
L_body7:
    s_waitcnt lgkmcnt(0)
    s_waitcnt vmcnt(24)
    v_mfma_f32_16x16x32_bf16 v[72:75], v[112:115], v[16:19], 0
    v_mfma_f32_16x16x32_bf16 v[72:75], v[116:119], v[20:23], v[72:75]
    v_mfma_f32_16x16x32_bf16 v[76:79], v[120:123], v[16:19], 0
    v_mfma_f32_16x16x32_bf16 v[76:79], v[124:127], v[20:23], v[76:79]
    buffer_load_dwordx4 v[112:115], v4, s[36:39], s44 offen offset:0 nt
    buffer_load_dwordx4 v[116:119], v4, s[36:39], s44 offen offset:256 nt
    buffer_load_dwordx4 v[120:123], v4, s[36:39], s44 offen offset:512 nt
    buffer_load_dwordx4 v[124:127], v4, s[36:39], s44 offen offset:768 nt
    s_waitcnt vmcnt(24)
    v_mfma_f32_16x16x32_bf16 v[80:83], v[128:131], v[16:19], 0
    v_mfma_f32_16x16x32_bf16 v[80:83], v[132:135], v[20:23], v[80:83]
    v_mfma_f32_16x16x32_bf16 v[84:87], v[136:139], v[16:19], 0
    v_mfma_f32_16x16x32_bf16 v[84:87], v[140:143], v[20:23], v[84:87]
    buffer_load_dwordx4 v[128:131], v4, s[36:39], s45 offen offset:0 nt
    buffer_load_dwordx4 v[132:135], v4, s[36:39], s45 offen offset:256 nt
    buffer_load_dwordx4 v[136:139], v4, s[36:39], s45 offen offset:512 nt
    buffer_load_dwordx4 v[140:143], v4, s[36:39], s45 offen offset:768 nt
    v_permlane32_swap_b32 v72, v76
    v_permlane32_swap_b32 v73, v77
    v_permlane32_swap_b32 v74, v78
    v_permlane32_swap_b32 v75, v79
    s_nop 0
    v_add_f32_dpp v36, v76, v72 quad_perm:[1,0,3,2] row_mask:0xf bank_mask:0xf
    v_add_f32_dpp v37, v77, v73 quad_perm:[1,0,3,2] row_mask:0xf bank_mask:0xf
    v_add_f32_dpp v38, v78, v74 quad_perm:[1,0,3,2] row_mask:0xf bank_mask:0xf
    v_add_f32_dpp v39, v79, v75 quad_perm:[1,0,3,2] row_mask:0xf bank_mask:0xf
    s_waitcnt vmcnt(24)
    v_mfma_f32_16x16x32_bf16 v[72:75], v[144:147], v[16:19], 0
    v_mfma_f32_16x16x32_bf16 v[72:75], v[148:151], v[20:23], v[72:75]
    v_mfma_f32_16x16x32_bf16 v[76:79], v[152:155], v[16:19], 0
    v_mfma_f32_16x16x32_bf16 v[76:79], v[156:159], v[20:23], v[76:79]
    buffer_load_dwordx4 v[144:147], v4, s[36:39], s46 offen offset:0 nt
    buffer_load_dwordx4 v[148:151], v4, s[36:39], s46 offen offset:256 nt
    buffer_load_dwordx4 v[152:155], v4, s[36:39], s46 offen offset:512 nt
    buffer_load_dwordx4 v[156:159], v4, s[36:39], s46 offen offset:768 nt
    v_permlane32_swap_b32 v80, v84
    v_permlane32_swap_b32 v81, v85
    v_permlane32_swap_b32 v82, v86
    v_permlane32_swap_b32 v83, v87
    s_nop 0
    v_add_f32_dpp v40, v84, v80 quad_perm:[1,0,3,2] row_mask:0xf bank_mask:0xf
    v_add_f32_dpp v41, v85, v81 quad_perm:[1,0,3,2] row_mask:0xf bank_mask:0xf
    v_add_f32_dpp v42, v86, v82 quad_perm:[1,0,3,2] row_mask:0xf bank_mask:0xf
    v_add_f32_dpp v43, v87, v83 quad_perm:[1,0,3,2] row_mask:0xf bank_mask:0xf
    s_waitcnt vmcnt(24)
    v_mfma_f32_16x16x32_bf16 v[80:83], v[160:163], v[16:19], 0
    v_mfma_f32_16x16x32_bf16 v[80:83], v[164:167], v[20:23], v[80:83]
    v_mfma_f32_16x16x32_bf16 v[84:87], v[168:171], v[16:19], 0
    v_mfma_f32_16x16x32_bf16 v[84:87], v[172:175], v[20:23], v[84:87]
    buffer_load_dwordx4 v[160:163], v4, s[36:39], s47 offen offset:0 nt
    buffer_load_dwordx4 v[164:167], v4, s[36:39], s47 offen offset:256 nt
    buffer_load_dwordx4 v[168:171], v4, s[36:39], s47 offen offset:512 nt
    buffer_load_dwordx4 v[172:175], v4, s[36:39], s47 offen offset:768 nt
    v_permlane32_swap_b32 v72, v76
    v_permlane32_swap_b32 v73, v77
    v_permlane32_swap_b32 v74, v78
    v_permlane32_swap_b32 v75, v79
    s_nop 0
    v_add_f32_dpp v44, v76, v72 quad_perm:[1,0,3,2] row_mask:0xf bank_mask:0xf
    v_add_f32_dpp v45, v77, v73 quad_perm:[1,0,3,2] row_mask:0xf bank_mask:0xf
    v_add_f32_dpp v46, v78, v74 quad_perm:[1,0,3,2] row_mask:0xf bank_mask:0xf
    v_add_f32_dpp v47, v79, v75 quad_perm:[1,0,3,2] row_mask:0xf bank_mask:0xf
    s_waitcnt vmcnt(24)
    v_mfma_f32_16x16x32_bf16 v[72:75], v[176:179], v[16:19], 0
    v_mfma_f32_16x16x32_bf16 v[72:75], v[180:183], v[20:23], v[72:75]
    v_mfma_f32_16x16x32_bf16 v[76:79], v[184:187], v[16:19], 0
    v_mfma_f32_16x16x32_bf16 v[76:79], v[188:191], v[20:23], v[76:79]
    buffer_load_dwordx4 v[176:179], v4, s[36:39], s48 offen offset:0 nt
    buffer_load_dwordx4 v[180:183], v4, s[36:39], s48 offen offset:256 nt
    buffer_load_dwordx4 v[184:187], v4, s[36:39], s48 offen offset:512 nt
    buffer_load_dwordx4 v[188:191], v4, s[36:39], s48 offen offset:768 nt
    v_permlane32_swap_b32 v80, v84
    v_permlane32_swap_b32 v81, v85
    v_permlane32_swap_b32 v82, v86
    v_permlane32_swap_b32 v83, v87
    s_nop 0
    v_add_f32_dpp v48, v84, v80 quad_perm:[1,0,3,2] row_mask:0xf bank_mask:0xf
    v_add_f32_dpp v49, v85, v81 quad_perm:[1,0,3,2] row_mask:0xf bank_mask:0xf
    v_add_f32_dpp v50, v86, v82 quad_perm:[1,0,3,2] row_mask:0xf bank_mask:0xf
    v_add_f32_dpp v51, v87, v83 quad_perm:[1,0,3,2] row_mask:0xf bank_mask:0xf
    s_waitcnt vmcnt(24)
    v_mfma_f32_16x16x32_bf16 v[80:83], v[192:195], v[16:19], 0
    v_mfma_f32_16x16x32_bf16 v[80:83], v[196:199], v[20:23], v[80:83]
    v_mfma_f32_16x16x32_bf16 v[84:87], v[200:203], v[16:19], 0
    v_mfma_f32_16x16x32_bf16 v[84:87], v[204:207], v[20:23], v[84:87]
    buffer_load_dwordx4 v[192:195], v4, s[36:39], s49 offen offset:0 nt
    buffer_load_dwordx4 v[196:199], v4, s[36:39], s49 offen offset:256 nt
    buffer_load_dwordx4 v[200:203], v4, s[36:39], s49 offen offset:512 nt
    buffer_load_dwordx4 v[204:207], v4, s[36:39], s49 offen offset:768 nt
    v_permlane32_swap_b32 v72, v76
    v_permlane32_swap_b32 v73, v77
    v_permlane32_swap_b32 v74, v78
    v_permlane32_swap_b32 v75, v79
    s_nop 0
    v_add_f32_dpp v52, v76, v72 quad_perm:[1,0,3,2] row_mask:0xf bank_mask:0xf
    v_add_f32_dpp v53, v77, v73 quad_perm:[1,0,3,2] row_mask:0xf bank_mask:0xf
    v_add_f32_dpp v54, v78, v74 quad_perm:[1,0,3,2] row_mask:0xf bank_mask:0xf
    v_add_f32_dpp v55, v79, v75 quad_perm:[1,0,3,2] row_mask:0xf bank_mask:0xf
    s_waitcnt vmcnt(24)
    v_mfma_f32_16x16x32_bf16 v[72:75], v[208:211], v[16:19], 0
    v_mfma_f32_16x16x32_bf16 v[72:75], v[212:215], v[20:23], v[72:75]
    v_mfma_f32_16x16x32_bf16 v[76:79], v[216:219], v[16:19], 0
    v_mfma_f32_16x16x32_bf16 v[76:79], v[220:223], v[20:23], v[76:79]
    buffer_load_dwordx4 v[208:211], v4, s[36:39], s50 offen offset:0 nt
    buffer_load_dwordx4 v[212:215], v4, s[36:39], s50 offen offset:256 nt
    buffer_load_dwordx4 v[216:219], v4, s[36:39], s50 offen offset:512 nt
    buffer_load_dwordx4 v[220:223], v4, s[36:39], s50 offen offset:768 nt
    v_permlane32_swap_b32 v80, v84
    v_permlane32_swap_b32 v81, v85
    v_permlane32_swap_b32 v82, v86
    v_permlane32_swap_b32 v83, v87
    s_nop 0
    v_add_f32_dpp v56, v84, v80 quad_perm:[1,0,3,2] row_mask:0xf bank_mask:0xf
    v_add_f32_dpp v57, v85, v81 quad_perm:[1,0,3,2] row_mask:0xf bank_mask:0xf
    v_add_f32_dpp v58, v86, v82 quad_perm:[1,0,3,2] row_mask:0xf bank_mask:0xf
    v_add_f32_dpp v59, v87, v83 quad_perm:[1,0,3,2] row_mask:0xf bank_mask:0xf
    s_nop 0
    v_permlane32_swap_b32 v72, v76
    v_permlane32_swap_b32 v73, v77
    v_permlane32_swap_b32 v74, v78
    v_permlane32_swap_b32 v75, v79
    s_nop 0
    v_add_f32_dpp v60, v76, v72 quad_perm:[1,0,3,2] row_mask:0xf bank_mask:0xf
    v_add_f32_dpp v61, v77, v73 quad_perm:[1,0,3,2] row_mask:0xf bank_mask:0xf
    v_add_f32_dpp v62, v78, v74 quad_perm:[1,0,3,2] row_mask:0xf bank_mask:0xf
    v_add_f32_dpp v63, v79, v75 quad_perm:[1,0,3,2] row_mask:0xf bank_mask:0xf
    v_max3_f32 v10, v36, v37, v38
    v_max3_f32 v10, v10, v39, v40
    v_max3_f32 v10, v10, v41, v42
    v_max3_f32 v10, v10, v43, v44
    v_max3_f32 v10, v10, v45, v46
    v_max3_f32 v10, v10, v47, v48
    v_max3_f32 v10, v10, v49, v50
    v_max3_f32 v10, v10, v51, v52
    v_max3_f32 v10, v10, v53, v54
    v_max3_f32 v10, v10, v55, v56
    v_max3_f32 v10, v10, v57, v58
    v_max3_f32 v10, v10, v59, v60
    v_max3_f32 v10, v10, v61, v62
    v_max_f32 v10, v10, v63
    v_mov_b32 v5, v10
    s_nop 1
    v_permlane16_swap_b32 v10, v5
    v_max_f32 v10, v10, v5
    v_mov_b32 v5, v10
    s_nop 1
    v_permlane32_swap_b32 v10, v5
    v_max_f32 v10, v10, v5
    v_mul_f32 v10, s71, v10
    v_fma_f32 v36, v36, s71, -v10
    v_fma_f32 v37, v37, s71, -v10
    v_fma_f32 v38, v38, s71, -v10
    v_fma_f32 v39, v39, s71, -v10
    v_fma_f32 v40, v40, s71, -v10
    v_fma_f32 v41, v41, s71, -v10
    v_fma_f32 v42, v42, s71, -v10
    v_fma_f32 v43, v43, s71, -v10
    v_fma_f32 v44, v44, s71, -v10
    v_fma_f32 v45, v45, s71, -v10
    v_fma_f32 v46, v46, s71, -v10
    v_fma_f32 v47, v47, s71, -v10
    v_fma_f32 v48, v48, s71, -v10
    v_fma_f32 v49, v49, s71, -v10
    v_fma_f32 v50, v50, s71, -v10
    v_fma_f32 v51, v51, s71, -v10
    v_fma_f32 v52, v52, s71, -v10
    v_fma_f32 v53, v53, s71, -v10
    v_fma_f32 v54, v54, s71, -v10
    v_fma_f32 v55, v55, s71, -v10
    v_fma_f32 v56, v56, s71, -v10
    v_fma_f32 v57, v57, s71, -v10
    v_fma_f32 v58, v58, s71, -v10
    v_fma_f32 v59, v59, s71, -v10
    v_fma_f32 v60, v60, s71, -v10
    v_fma_f32 v61, v61, s71, -v10
    v_fma_f32 v62, v62, s71, -v10
    v_fma_f32 v63, v63, s71, -v10
    v_exp_f32 v36, v36
    v_exp_f32 v37, v37
    v_exp_f32 v38, v38
    v_exp_f32 v39, v39
    v_exp_f32 v40, v40
    v_exp_f32 v41, v41
    v_exp_f32 v42, v42
    v_exp_f32 v43, v43
    v_exp_f32 v44, v44
    v_exp_f32 v45, v45
    v_exp_f32 v46, v46
    v_exp_f32 v47, v47
    v_exp_f32 v48, v48
    v_exp_f32 v49, v49
    v_exp_f32 v50, v50
    v_exp_f32 v51, v51
    v_exp_f32 v52, v52
    v_exp_f32 v53, v53
    v_exp_f32 v54, v54
    v_exp_f32 v55, v55
    v_exp_f32 v56, v56
    v_exp_f32 v57, v57
    v_exp_f32 v58, v58
    v_exp_f32 v59, v59
    v_exp_f32 v60, v60
    v_exp_f32 v61, v61
    v_exp_f32 v62, v62
    v_exp_f32 v63, v63
    s_mov_b64 exec, s[56:57]
    ds_write_b32 v11, v10 offset:17408
    s_mov_b64 exec, -1
    v_cvt_pk_bf16_f32 v16, v36, v37
    v_cvt_pk_bf16_f32 v17, v38, v39
    v_cvt_pk_bf16_f32 v18, v40, v41
    v_cvt_pk_bf16_f32 v19, v42, v43
    v_cvt_pk_bf16_f32 v20, v44, v45
    v_cvt_pk_bf16_f32 v21, v46, v47
    v_cvt_pk_bf16_f32 v22, v48, v49
    v_cvt_pk_bf16_f32 v23, v50, v51
    v_cvt_pk_bf16_f32 v24, v52, v53
    v_cvt_pk_bf16_f32 v25, v54, v55
    v_cvt_pk_bf16_f32 v26, v56, v57
    v_cvt_pk_bf16_f32 v27, v58, v59
    v_cvt_pk_bf16_f32 v28, v60, v61
    v_cvt_pk_bf16_f32 v29, v62, v63
    s_nop 1
    v_mfma_f32_16x16x32_bf16 v[104:107], v[16:19], v[108:111], 0
    v_mfma_f32_16x16x32_bf16 v[104:107], v[20:23], v[108:111], v[104:107]
    v_mfma_f32_16x16x32_bf16 v[104:107], v[24:27], v[108:111], v[104:107]
    s_nop 5
    v_mfma_f32_16x16x16_bf16 v[104:107], v[28:29], v[108:109], v[104:107]
    v_mov_b32 v5, 1
    s_nop 6
    ds_write_b32 v14, v104 offset:17412
    s_mov_b64 exec, 1
    ds_add_u32 v13, v5 offset:17796
    s_mov_b64 exec, -1
    s_waitcnt vmcnt(26)
    v_perm_b32 v36, v116, v112, s30
    v_perm_b32 v40, v116, v112, s31
    v_perm_b32 v44, v117, v113, s30
    v_perm_b32 v48, v117, v113, s31
    v_perm_b32 v52, v118, v114, s30
    v_perm_b32 v56, v118, v114, s31
    v_perm_b32 v60, v119, v115, s30
    v_perm_b32 v64, v119, v115, s31
    s_waitcnt vmcnt(24)
    v_perm_b32 v37, v124, v120, s30
    v_perm_b32 v41, v124, v120, s31
    v_perm_b32 v45, v125, v121, s30
    v_perm_b32 v49, v125, v121, s31
    v_perm_b32 v53, v126, v122, s30
    v_perm_b32 v57, v126, v122, s31
    v_perm_b32 v61, v127, v123, s30
    v_perm_b32 v65, v127, v123, s31
    s_waitcnt vmcnt(22)
    v_perm_b32 v38, v132, v128, s30
    v_perm_b32 v42, v132, v128, s31
    v_perm_b32 v46, v133, v129, s30
    v_perm_b32 v50, v133, v129, s31
    v_perm_b32 v54, v134, v130, s30
    v_perm_b32 v58, v134, v130, s31
    v_perm_b32 v62, v135, v131, s30
    v_perm_b32 v66, v135, v131, s31
    s_waitcnt vmcnt(20)
    v_perm_b32 v39, v140, v136, s30
    v_perm_b32 v43, v140, v136, s31
    v_perm_b32 v47, v141, v137, s30
    v_mfma_f32_16x16x32_bf16 v[72:75], v[16:19], v[36:39], 0
    v_perm_b32 v51, v141, v137, s31
    v_mfma_f32_16x16x32_bf16 v[76:79], v[16:19], v[40:43], 0
    v_perm_b32 v55, v142, v138, s30
    v_mfma_f32_16x16x32_bf16 v[80:83], v[16:19], v[44:47], 0
    v_perm_b32 v59, v142, v138, s31
    v_mfma_f32_16x16x32_bf16 v[84:87], v[16:19], v[48:51], 0
    v_perm_b32 v63, v143, v139, s30
    v_mfma_f32_16x16x32_bf16 v[88:91], v[16:19], v[52:55], 0
    v_perm_b32 v67, v143, v139, s31
    v_mfma_f32_16x16x32_bf16 v[92:95], v[16:19], v[56:59], 0
    v_mfma_f32_16x16x32_bf16 v[96:99], v[16:19], v[60:63], 0
    v_mfma_f32_16x16x32_bf16 v[100:103], v[16:19], v[64:67], 0
    s_waitcnt vmcnt(18)
    v_perm_b32 v36, v148, v144, s30
    v_perm_b32 v40, v148, v144, s31
    v_perm_b32 v44, v149, v145, s30
    v_perm_b32 v48, v149, v145, s31
    v_perm_b32 v52, v150, v146, s30
    v_perm_b32 v56, v150, v146, s31
    v_perm_b32 v60, v151, v147, s30
    v_perm_b32 v64, v151, v147, s31
    s_waitcnt vmcnt(16)
    v_perm_b32 v37, v156, v152, s30
    v_perm_b32 v41, v156, v152, s31
    v_perm_b32 v45, v157, v153, s30
    v_perm_b32 v49, v157, v153, s31
    v_perm_b32 v53, v158, v154, s30
    v_perm_b32 v57, v158, v154, s31
    v_perm_b32 v61, v159, v155, s30
    v_perm_b32 v65, v159, v155, s31
    s_waitcnt vmcnt(14)
    v_perm_b32 v38, v164, v160, s30
    v_perm_b32 v42, v164, v160, s31
    v_perm_b32 v46, v165, v161, s30
    v_perm_b32 v50, v165, v161, s31
    v_perm_b32 v54, v166, v162, s30
    v_perm_b32 v58, v166, v162, s31
    v_perm_b32 v62, v167, v163, s30
    v_perm_b32 v66, v167, v163, s31
    s_waitcnt vmcnt(12)
    v_perm_b32 v39, v172, v168, s30
    v_perm_b32 v43, v172, v168, s31
    v_perm_b32 v47, v173, v169, s30
    v_mfma_f32_16x16x32_bf16 v[72:75], v[20:23], v[36:39], v[72:75]
    v_perm_b32 v51, v173, v169, s31
    v_mfma_f32_16x16x32_bf16 v[76:79], v[20:23], v[40:43], v[76:79]
    v_perm_b32 v55, v174, v170, s30
    v_mfma_f32_16x16x32_bf16 v[80:83], v[20:23], v[44:47], v[80:83]
    v_perm_b32 v59, v174, v170, s31
    v_mfma_f32_16x16x32_bf16 v[84:87], v[20:23], v[48:51], v[84:87]
    v_perm_b32 v63, v175, v171, s30
    v_mfma_f32_16x16x32_bf16 v[88:91], v[20:23], v[52:55], v[88:91]
    v_perm_b32 v67, v175, v171, s31
    v_mfma_f32_16x16x32_bf16 v[92:95], v[20:23], v[56:59], v[92:95]
    v_mfma_f32_16x16x32_bf16 v[96:99], v[20:23], v[60:63], v[96:99]
    v_mfma_f32_16x16x32_bf16 v[100:103], v[20:23], v[64:67], v[100:103]
    s_waitcnt vmcnt(10)
    v_perm_b32 v36, v180, v176, s30
    v_perm_b32 v40, v180, v176, s31
    v_perm_b32 v44, v181, v177, s30
    v_perm_b32 v48, v181, v177, s31
    v_perm_b32 v52, v182, v178, s30
    v_perm_b32 v56, v182, v178, s31
    v_perm_b32 v60, v183, v179, s30
    v_perm_b32 v64, v183, v179, s31
    s_waitcnt vmcnt(8)
    v_perm_b32 v37, v188, v184, s30
    v_perm_b32 v41, v188, v184, s31
    v_perm_b32 v45, v189, v185, s30
    v_perm_b32 v49, v189, v185, s31
    v_perm_b32 v53, v190, v186, s30
    v_perm_b32 v57, v190, v186, s31
    v_perm_b32 v61, v191, v187, s30
    v_perm_b32 v65, v191, v187, s31
    s_waitcnt vmcnt(6)
    v_perm_b32 v38, v196, v192, s30
    v_perm_b32 v42, v196, v192, s31
    v_perm_b32 v46, v197, v193, s30
    v_perm_b32 v50, v197, v193, s31
    v_perm_b32 v54, v198, v194, s30
    v_perm_b32 v58, v198, v194, s31
    v_perm_b32 v62, v199, v195, s30
    v_perm_b32 v66, v199, v195, s31
    s_waitcnt vmcnt(4)
    v_perm_b32 v39, v204, v200, s30
    v_perm_b32 v43, v204, v200, s31
    v_perm_b32 v47, v205, v201, s30
    v_mfma_f32_16x16x32_bf16 v[72:75], v[24:27], v[36:39], v[72:75]
    v_perm_b32 v51, v205, v201, s31
    v_mfma_f32_16x16x32_bf16 v[76:79], v[24:27], v[40:43], v[76:79]
    v_perm_b32 v55, v206, v202, s30
    v_mfma_f32_16x16x32_bf16 v[80:83], v[24:27], v[44:47], v[80:83]
    v_perm_b32 v59, v206, v202, s31
    v_mfma_f32_16x16x32_bf16 v[84:87], v[24:27], v[48:51], v[84:87]
    v_perm_b32 v63, v207, v203, s30
    v_mfma_f32_16x16x32_bf16 v[88:91], v[24:27], v[52:55], v[88:91]
    v_perm_b32 v67, v207, v203, s31
    v_mfma_f32_16x16x32_bf16 v[92:95], v[24:27], v[56:59], v[92:95]
    v_mfma_f32_16x16x32_bf16 v[96:99], v[24:27], v[60:63], v[96:99]
    v_mfma_f32_16x16x32_bf16 v[100:103], v[24:27], v[64:67], v[100:103]
    s_waitcnt vmcnt(2)
    v_perm_b32 v36, v212, v208, s30
    v_perm_b32 v40, v212, v208, s31
    v_perm_b32 v44, v213, v209, s30
    v_perm_b32 v48, v213, v209, s31
    v_perm_b32 v52, v214, v210, s30
    v_perm_b32 v56, v214, v210, s31
    v_perm_b32 v60, v215, v211, s30
    v_perm_b32 v64, v215, v211, s31
    s_waitcnt vmcnt(0)
    v_perm_b32 v37, v220, v216, s30
    v_perm_b32 v41, v220, v216, s31
    v_perm_b32 v45, v221, v217, s30
    v_mfma_f32_16x16x16_bf16 v[72:75], v[28:29], v[36:37], v[72:75]
    v_perm_b32 v49, v221, v217, s31
    v_mfma_f32_16x16x16_bf16 v[76:79], v[28:29], v[40:41], v[76:79]
    v_perm_b32 v53, v222, v218, s30
    v_mfma_f32_16x16x16_bf16 v[80:83], v[28:29], v[44:45], v[80:83]
    v_perm_b32 v57, v222, v218, s31
    v_mfma_f32_16x16x16_bf16 v[84:87], v[28:29], v[48:49], v[84:87]
    v_perm_b32 v61, v223, v219, s30
    v_mfma_f32_16x16x16_bf16 v[88:91], v[28:29], v[52:53], v[88:91]
    v_perm_b32 v65, v223, v219, s31
    v_mfma_f32_16x16x16_bf16 v[92:95], v[28:29], v[56:57], v[92:95]
    v_mfma_f32_16x16x16_bf16 v[96:99], v[28:29], v[60:61], v[96:99]
    v_mfma_f32_16x16x16_bf16 v[100:103], v[28:29], v[64:65], v[100:103]
L_pvdone:
    s_nop 0
    ds_write2st64_b32 v15, v72, v76 offset0:0 offset1:1
    ds_write2st64_b32 v15, v80, v84 offset0:2 offset1:3
    s_nop 2
    ds_write2st64_b32 v15, v88, v92 offset0:4 offset1:5
    s_nop 1
    ds_write2st64_b32 v15, v96, v100 offset0:6 offset1:7
    s_cmp_ge_u32 s23, 4
    s_cbranch_scc1 L_late
    s_mov_b64 exec, 1
    ds_add_u32 v13, v5 offset:17804
    s_mov_b64 exec, -1
    v_lshlrev_b32 v3, 1, v1
    v_xor_b32 v3, v3, v2
    v_lshlrev_b32 v3, 4, v3
    v_lshl_add_u32 v3, v1, 10, v3
    v_xor_b32 v4, 0x80, v3
    s_lshl_b32 s3, s23, 9
    v_add_u32 v11, s3, v8
    v_and_b32 v15, 1, v1
    v_lshl_add_u32 v15, v15, 2, v9
    v_xor_b32 v15, s23, v15
    v_lshl_add_u32 v14, v1, 3, v9
    v_lshlrev_b32 v14, 8, v14
    v_lshl_add_u32 v14, v15, 5, v14
    v_and_b32 v15, 3, v2
    v_lshl_add_u32 v14, v15, 3, v14
    v_xor_b32 v98, 0x80, v14
    v_mul_u32_u24 v15, 272, v2
    v_lshl_add_u32 v15, v1, 4, v15
    v_lshlrev_b32 v101, 4, v1
    s_lshl_b32 s3, s54, 14
    s_lshl_b32 s29, s25, 12
    s_add_u32 s3, s3, s29
    s_lshl_b32 s29, s23, 10
    s_add_u32 s7, s3, s29
    v_lshlrev_b32 v97, 4, v0
    s_mov_b32 s56, 0x55555555
    s_mov_b32 s57, 0x55555555
    v_mov_b32 v5, 1
    s_lshl_b32 s6, s25, 5
    s_add_u32 s6, s6, s54
    v_lshrrev_b32 v8, 1, v0
    v_and_b32 v9, 1, v0
    s_lshl_b32 s4, s23, 1
    v_add_u32 v9, s4, v9
    v_lshlrev_b32 v8, 14, v8
    v_lshl_add_u32 v8, v9, 4, v8
    s_lshl_b32 s29, s6, 7
    v_add_u32 v8, s29, v8
    s_bfe_u32 s4, s6, 0x20001
    s_lshl_b32 s4, s4, 11
    s_lshl_b32 s5, s28, 10
    s_add_u32 s4, s4, s5
    s_lshl_b32 s5, s25, 8
    s_add_u32 s4, s4, s5
    s_and_b32 s5, s6, 1
    s_lshl_b32 s5, s5, 4
    s_add_u32 s4, s4, s5
    s_bfe_u32 s5, s6, 0x20003
    s_lshl_b32 s5, s5, 5
    s_add_u32 s4, s4, s5
    v_lshlrev_b32 v9, 1, v9
    v_add_u32 v9, s4, v9
    v_lshrrev_b32 v7, 5, v0
    v_lshl_add_u32 v9, v7, 7, v9
    s_mov_b32 s29, 2000000
L_cnt:
    ds_read_b32 v10, v13 offset:17796
    s_waitcnt lgkmcnt(0)
    v_readfirstlane_b32 s4, v10
    s_cmp_ge_u32 s4, 8
    s_cbranch_scc1 L_cntok
    s_sleep 2
    s_branch L_cnt
L_cntok:
    ds_read_b128 v[16:19], v12 offset:17408
    ds_read_b128 v[20:23], v12 offset:17424
    ds_read_b128 v[24:27], v12 offset:17440
    ds_read_b128 v[28:31], v12 offset:17456
    s_add_u32 m0, s16, 0
    s_mov_b32 s3, 0
    buffer_load_dwordx4 v3, s[12:15], s3 offen nt lds
    s_add_u32 m0, s16, 1024
    s_mov_b32 s3, 4096
    buffer_load_dwordx4 v3, s[12:15], s3 offen nt lds
    s_add_u32 m0, s16, 2048
    s_mov_b32 s3, 8192
    buffer_load_dwordx4 v4, s[12:15], s3 offen nt lds
    s_add_u32 m0, s16, 3072
    s_mov_b32 s3, 12288
    buffer_load_dwordx4 v4, s[12:15], s3 offen nt lds
    v_mov_b32 v81, s22
    v_mov_b32 v83, s22
    v_mov_b32 v33, s22
    s_waitcnt lgkmcnt(0)
    v_max3_f32 v44, v16, v18, v20
    v_max3_f32 v44, v44, v22, v24
    v_max3_f32 v44, v44, v26, v28
    v_max_f32 v44, v44, v30
    v_sub_f32 v36, v16, v44
    v_sub_f32 v37, v18, v44
    v_sub_f32 v38, v20, v44
    v_sub_f32 v39, v22, v44
    v_sub_f32 v40, v24, v44
    v_sub_f32 v41, v26, v44
    v_sub_f32 v42, v28, v44
    v_sub_f32 v43, v30, v44
    v_exp_f32 v36, v36
    v_exp_f32 v37, v37
    v_exp_f32 v38, v38
    v_exp_f32 v39, v39
    v_exp_f32 v40, v40
    v_exp_f32 v41, v41
    v_exp_f32 v42, v42
    v_exp_f32 v43, v43
    s_nop 0
    v_mul_f32 v46, v36, v17
    v_fmac_f32 v46, v37, v19
    v_fmac_f32 v46, v38, v21
    v_fmac_f32 v46, v39, v23
    v_fmac_f32 v46, v40, v25
    v_fmac_f32 v46, v41, v27
    v_fmac_f32 v46, v42, v29
    v_fmac_f32 v46, v43, v31
    v_log_f32 v45, v46
    v_rcp_f32 v46, v46
    s_nop 0
    v_add_f32 v35, v44, v45
    v_mul_f32 v36, v36, v46
    v_mul_f32 v37, v37, v46
    v_mul_f32 v38, v38, v46
    v_mul_f32 v39, v39, v46
    v_mul_f32 v40, v40, v46
    v_mul_f32 v41, v41, v46
    v_mul_f32 v42, v42, v46
    v_mul_f32 v43, v43, v46
    v_xor_b32 v35, s22, v35
L_ps:
    ds_read_b32 v10, v13 offset:17804
    s_waitcnt lgkmcnt(0)
    v_readfirstlane_b32 s4, v10
    s_cmp_ge_u32 s4, 4
    s_cbranch_scc0 L_ps
    ds_read2st64_b32 v[16:17], v11 offset0:0 offset1:1
    ds_read2st64_b32 v[18:19], v11 offset0:8 offset1:9
    ds_read2st64_b32 v[20:21], v11 offset0:16 offset1:17
    ds_read2st64_b32 v[22:23], v11 offset0:24 offset1:25
    s_waitcnt lgkmcnt(3)
    v_mul_f32 v32, v36, v16
    v_mul_f32 v34, v36, v17
    s_waitcnt lgkmcnt(2)
    v_fmac_f32 v32, v37, v18
    v_fmac_f32 v34, v37, v19
    s_waitcnt lgkmcnt(1)
    v_fmac_f32 v32, v38, v20
    v_fmac_f32 v34, v38, v21
    s_waitcnt lgkmcnt(0)
    v_fmac_f32 v32, v39, v22
    v_fmac_f32 v34, v39, v23
    s_barrier
    ds_read2st64_b32 v[24:25], v11 offset0:32 offset1:33
    ds_read2st64_b32 v[26:27], v11 offset0:40 offset1:41
    ds_read2st64_b32 v[28:29], v11 offset0:48 offset1:49
    ds_read2st64_b32 v[30:31], v11 offset0:56 offset1:57
    s_waitcnt lgkmcnt(3)
    v_fmac_f32 v32, v40, v24
    v_fmac_f32 v34, v40, v25
    s_waitcnt lgkmcnt(2)
    v_fmac_f32 v32, v41, v26
    v_fmac_f32 v34, v41, v27
    s_waitcnt lgkmcnt(1)
    v_fmac_f32 v32, v42, v28
    v_fmac_f32 v34, v42, v29
    s_waitcnt lgkmcnt(0)
    v_fmac_f32 v32, v43, v30
    v_fmac_f32 v34, v43, v31
    v_cvt_pk_bf16_f32 v32, v32, v34
    s_nop 1
    v_mov_b32_dpp v34, v32 quad_perm:[1,0,3,2] row_mask:0xf bank_mask:0xf
    s_mov_b64 exec, s[56:57]
    global_store_dwordx4 v6, v[32:35], s[60:61] sc1
    s_mov_b64 exec, -1
    s_add_u32 m0, s16, 4096
    s_mov_b32 s3, 16384
    buffer_load_dwordx4 v3, s[12:15], s3 offen nt lds
    s_add_u32 m0, s16, 5120
    s_mov_b32 s3, 20480
    buffer_load_dwordx4 v3, s[12:15], s3 offen nt lds
    s_add_u32 m0, s16, 6144
    s_mov_b32 s3, 24576
    buffer_load_dwordx4 v4, s[12:15], s3 offen nt lds
    s_add_u32 m0, s16, 7168
    s_mov_b32 s3, 28672
    buffer_load_dwordx4 v4, s[12:15], s3 offen nt lds
    buffer_load_dword v148, v97, s[64:67], s7 offen sc1
    global_load_dword v149, v13, s[18:19]
    s_waitcnt vmcnt(2)
    s_mov_b64 exec, 1
    ds_add_u32 v13, v5 offset:17800
    s_mov_b64 exec, -1
L_bf:
    ds_read_b32 v16, v13 offset:17800
    s_waitcnt lgkmcnt(0)
    v_readfirstlane_b32 s4, v16
    s_cmp_ge_u32 s4, 4
    s_cbranch_scc0 L_bf
    ds_read_b64_tr_b16 v[48:49], v14 offset:32768
    ds_read_b64_tr_b16 v[50:51], v14 offset:33792
    ds_read_b64_tr_b16 v[52:53], v14 offset:40960
    ds_read_b64_tr_b16 v[54:55], v14 offset:41984
    ds_read_b64_tr_b16 v[56:57], v14 offset:49152
    ds_read_b64_tr_b16 v[58:59], v14 offset:50176
    ds_read_b64_tr_b16 v[60:61], v14 offset:57344
    ds_read_b64_tr_b16 v[62:63], v14 offset:58368
    s_waitcnt lgkmcnt(0)
    ds_read_b64_tr_b16 v[64:65], v98 offset:32768
    ds_read_b64_tr_b16 v[66:67], v98 offset:33792
    ds_read_b64_tr_b16 v[68:69], v98 offset:40960
    ds_read_b64_tr_b16 v[70:71], v98 offset:41984
    ds_read_b64_tr_b16 v[72:73], v98 offset:49152
    ds_read_b64_tr_b16 v[74:75], v98 offset:50176
    ds_read_b64_tr_b16 v[76:77], v98 offset:57344
    ds_read_b64_tr_b16 v[78:79], v98 offset:58368
    s_waitcnt lgkmcnt(0)
    s_barrier
    ds_read_b128 v[40:43], v101 offset:17920
    ds_read_b128 v[16:19], v15 offset:18432
    ds_read_b128 v[20:23], v15 offset:18496
    ds_read_b128 v[24:27], v15 offset:18560
    ds_read_b128 v[28:31], v15 offset:18624
    s_waitcnt lgkmcnt(3)
    v_mfma_f32_16x16x32_bf16 v[32:35], v[16:19], v[48:51], 0
    v_max3_f32 v44, v40, v41, v42
    v_max_f32 v44, v44, v43
    v_mfma_f32_16x16x32_bf16 v[36:39], v[16:19], v[64:67], 0
    v_sub_f32 v40, v40, v44
    v_sub_f32 v41, v41, v44
    s_waitcnt lgkmcnt(2)
    v_mfma_f32_16x16x32_bf16 v[32:35], v[20:23], v[52:55], v[32:35]
    v_sub_f32 v42, v42, v44
    v_sub_f32 v43, v43, v44
    v_mfma_f32_16x16x32_bf16 v[36:39], v[20:23], v[68:71], v[36:39]
    v_exp_f32 v40, v40
    s_waitcnt lgkmcnt(1)
    v_mfma_f32_16x16x32_bf16 v[32:35], v[24:27], v[56:59], v[32:35]
    v_exp_f32 v41, v41
    v_mfma_f32_16x16x32_bf16 v[36:39], v[24:27], v[72:75], v[36:39]
    v_exp_f32 v42, v42
    s_waitcnt lgkmcnt(0)
    v_mfma_f32_16x16x32_bf16 v[32:35], v[28:31], v[60:63], v[32:35]
    v_exp_f32 v43, v43
    v_mfma_f32_16x16x32_bf16 v[36:39], v[28:31], v[76:79], v[36:39]
    v_add_f32 v44, v40, v41
    v_add_f32 v45, v42, v43
    v_add_f32 v44, v44, v45
    v_rcp_f32 v44, v44
    s_bitcmp1_b32 s53, 1
    s_nop 0
    v_mul_f32 v80, v40, v32
    v_fmac_f32 v80, v41, v33
    v_mul_f32 v82, v40, v36
    v_fmac_f32 v82, v41, v37
    v_fmac_f32 v80, v42, v34
    v_fmac_f32 v82, v42, v38
    v_fmac_f32 v80, v43, v35
    v_fmac_f32 v82, v43, v39
    v_mul_f32 v80, v80, v44
    v_mul_f32 v82, v82, v44
    s_cbranch_scc1 L_ostl
    buffer_store_dwordx4 v[80:83], v97, s[64:67], s7 offen sc1
    s_branch L_ostd
L_ostl:
    buffer_store_dwordx4 v[80:83], v97, s[64:67], s7 offen
L_ostd:
L_f4:
    buffer_load_dwordx4 v[16:19], v8, s[64:67], 0 offen sc1
    s_waitcnt vmcnt(0)
    v_cmpx_eq_u32 vcc, s22, v17
    v_cmpx_eq_u32 vcc, s22, v19
    s_cmp_eq_u64 exec, -1
    s_mov_b64 exec, -1
    s_cbranch_scc1 L_f4ok
    s_sub_u32 s29, s29, 1
    s_cbranch_scc0 L_f4
L_f4ok:
    s_nop 0
    v_permlane32_swap_b32 v16, v18
    v_add_f32 v16, v16, v18
    s_nop 1
    v_add_f32_dpp v16, v16, v16 quad_perm:[2,3,0,1] row_mask:0xf bank_mask:0xf
    s_nop 1
    v_add_f32_dpp v16, v16, v16 row_ror:4 row_mask:0xf bank_mask:0xf
    s_nop 1
    v_add_f32_dpp v16, v16, v16 row_ror:8 row_mask:0xf bank_mask:0xf
    v_mov_b32 v17, v16
    s_nop 1
    v_permlane16_swap_b32 v16, v17
    v_add_f32 v16, v16, v17
    s_mov_b32 exec_lo, 3
    s_mov_b32 exec_hi, 3
    v_cvt_pk_bf16_f32 v16, v16, v16
    global_store_short v9, v16, s[18:19]
    s_or_b32 s6, s6, s23
    s_branch L_ep
L_late:
    s_waitcnt lgkmcnt(0)
    s_barrier
    s_atomic_add s17, s[58:59], 0
    v_lshrrev_b32 v11, 5, v0
    v_mul_u32_u24 v10, 272, v11
    v_and_b32 v12, 7, v0
    v_lshl_add_u32 v10, v12, 5, v10
    v_bfe_u32 v12, v0, 3, 2
    v_lshl_add_u32 v10, v12, 2, v10
    s_mul_i32 s3, s63, 1088
    s_add_u32 s3, s3, 18432
    v_add_u32 v10, s3, v10
    s_lshl_b32 s3, s63, 4
    s_add_u32 s3, s3, 17920
    v_lshlrev_b32 v11, 2, v11
    v_add_u32 v11, s3, v11
    s_mov_b32 s29, 2000000
L_sg:
    s_load_dwordx2 s[4:5], s[10:11], 0 glc
    s_waitcnt lgkmcnt(0)
    s_cmp_eq_u32 s5, s22
    s_cselect_b32 s4, s4, 0
    s_cmp_ge_u32 s4, 4
    s_cbranch_scc1 L_sgok
    s_cmp_ge_u32 s4, 3
    s_cbranch_scc1 L_sg3
    s_sleep 4
L_sg3:
    s_sub_u32 s29, s29, 1
    s_cbranch_scc0 L_sg
    s_mov_b32 s29, 0
L_sgok:
    global_load_dwordx4 v[16:19], v7, s[60:61] offset:0 sc1
    global_load_dwordx4 v[20:23], v7, s[60:61] offset:1024 sc1
L_opoll:
    s_waitcnt vmcnt(0)
    v_mov_b32_dpp v32, v19 row_ror:1 row_mask:0xf bank_mask:0xf
    v_mov_b32_dpp v33, v23 row_ror:1 row_mask:0xf bank_mask:0xf
    v_cmpx_eq_u32 vcc, s22, v17
    v_cmpx_eq_u32 vcc, s22, v21
    v_cmpx_eq_u32 vcc, v32, v19
    v_cmpx_eq_u32 vcc, v33, v23
    s_cmp_eq_u64 exec, -1
    s_mov_b64 exec, -1
    s_cbranch_scc1 L_opoll_ok
    v_cmp_ne_u32 s[44:45], s22, v17
    v_cmp_ne_u32 s[46:47], s22, v21
    s_or_b64 s[72:73], s[44:45], s[46:47]
    s_cbranch_scc1 L_opoll_r
    s_mov_b64 s[44:45], -1
    s_mov_b64 s[46:47], -1
L_opoll_r:
    s_sub_u32 s29, s29, 1
    s_cbranch_scc1 L_opoll_ok
    s_mov_b64 exec, s[44:45]
    s_cbranch_execz L_opoll_s0
    global_load_dwordx4 v[16:19], v7, s[60:61] offset:0 sc1
L_opoll_s0:
    s_mov_b64 exec, s[46:47]
    s_cbranch_execz L_opoll_s1
    global_load_dwordx4 v[20:23], v7, s[60:61] offset:1024 sc1
L_opoll_s1:
    s_mov_b64 exec, -1
    s_branch L_opoll
L_opoll_ok:
    ds_write2_b32 v10, v16, v18 offset0:0 offset1:4
    ds_write2_b32 v10, v20, v22 offset0:136 offset1:140
    v_xor_b32 v19, s22, v19
    v_xor_b32 v23, s22, v23
    s_mov_b32 exec_lo, 1
    s_mov_b32 exec_hi, 1
    ds_write2_b32 v11, v19, v23 offset0:0 offset1:2
    s_waitcnt lgkmcnt(0)
    s_barrier
    s_branch L_end
L_ep:
    s_mov_b64 exec, 1
    s_cmp_lg_u32 s6, 0
    s_cbranch_scc1 L_noep
    global_store_dword v13, v81, s[74:75]
L_noep:
L_end:
    s_endpgm
.section .rodata,"a"
.p2align 6
.amdhsa_kernel concat_heads__gqa_block_cached__gqa_block_cached__decode_kernel
  .amdhsa_next_free_vgpr 256
  .amdhsa_next_free_sgpr 76
  .amdhsa_accum_offset 256
  .amdhsa_group_segment_fixed_size 0
  .amdhsa_kernarg_size 104
  .amdhsa_user_sgpr_count 2
  .amdhsa_user_sgpr_kernarg_segment_ptr 1
  .amdhsa_system_sgpr_workgroup_id_x 1
.end_amdhsa_kernel
```
